```python
import torch

def _softmax(x, axis=-1):
    return torch.softmax(x, dim=axis)
def _gelu(x):
    return torch.nn.functional.gelu(x, approximate="tanh")
def _silu(x):
    return torch.nn.functional.silu(x)
def _sigmoid(x):
    return torch.sigmoid(x)
def _layernorm(x, axis=-1, eps=1e-5):
    m = x.mean(dim=axis, keepdim=True)
    v = x.var(dim=axis, keepdim=True, unbiased=False)
    return (x - m) / torch.sqrt(v + eps)
def _scatter_add(tgt, idx, src, axis=0):
    return tgt.clone().index_add_(axis, idx, src)
def _segment_sum(src, seg, n):
    out = torch.zeros((n,) + src.shape[1:], dtype=src.dtype)
    return out.index_add_(0, seg, src)
def _pad(x, pw):
    flat = tuple(v for pair in reversed(pw) for v in pair)
    return torch.nn.functional.pad(x, flat)

kernel_name = 'parallel_sum__linear_kernel_hedgehog__moe_arch_mod__prompt'

def setup_inputs():

    _w = (lambda a: (lambda t: t.to(torch.bfloat16) if t.is_floating_point() else t)(torch.as_tensor(a)))
    def _A_setup():
        B, S, D, H = 1, 2048, 640, 32
        Dh = D // H
        return {
            "x": _w((lambda *s: torch.randn(*s, dtype=torch.bfloat16) * 0.05)(B, S, D)),
            "wqkv": _w((lambda *s: torch.randn(*s, dtype=torch.bfloat16) * 0.4)(D, 3 * D)),
            "w_phi": _w((lambda *s: torch.randn(*s, dtype=torch.bfloat16) * 0.4)(H, Dh, Dh) * (Dh ** -0.5)),
            "wo": _w((lambda *s: torch.randn(*s, dtype=torch.bfloat16) * 0.1)(D, D)),
        }
    _A_in = _A_setup()

    def _B_setup():
        B, S, D, F, C = 1, 2048, 640, 1536, 2
        return {
            "x": _w((lambda *s: torch.randn(*s, dtype=torch.bfloat16) * 0.05)(B, S, D)),
            "w_r": _w((lambda *s: torch.randn(*s, dtype=torch.bfloat16) * 0.05)(D)),
            "w_gate": _w((lambda *s: torch.randn(*s, dtype=torch.bfloat16) * 0.05)(D, F)),
            "w_up": _w((lambda *s: torch.randn(*s, dtype=torch.bfloat16) * 0.05)(D, F)),
            "w_down": _w((lambda *s: torch.randn(*s, dtype=torch.bfloat16) * 0.05)(F, D)),
        }
    _B_in = _B_setup()

    return {
        "A_x": _A_in["x"],
        "A_wqkv": _A_in["wqkv"],
        "A_w_phi": _A_in["w_phi"],
        "A_wo": _A_in["wo"],
        "B_x": _B_in["x"],
        "B_w_r": _B_in["w_r"],
        "B_w_gate": _B_in["w_gate"],
        "B_w_up": _B_in["w_up"],
        "B_w_down": _B_in["w_down"],
    }

def reference(A_x, A_wqkv, A_w_phi, A_wo, B_x, B_w_r, B_w_gate, B_w_up, B_w_down):
    def _A_ref(x, wqkv, w_phi, wo):
        B, S, D = x.shape
        H = 32; Dh = D // H
        qkv = (lambda x, *d: x.permute(*d))((x @ wqkv).reshape(B, S, 3, H, Dh), 2, 0, 3, 1, 4)
        q, k, v = qkv[0], qkv[1], qkv[2]
        pq = torch.einsum("bhsd,hdf->bhsf", q, w_phi)
        pk = torch.einsum("bhsd,hdf->bhsf", k, w_phi)
        phi_q = torch.concatenate([_softmax(pq, axis=-1), _softmax(-pq, axis=-1)], axis=-1)
        phi_k = torch.concatenate([_softmax(pk, axis=-1), _softmax(-pk, axis=-1)], axis=-1)
        kv = torch.einsum("bhsf,bhsd->bhfd", phi_k, v)
        z  = torch.einsum("bhsf->bhf", phi_k)
        num = torch.einsum("bhqf,bhfd->bhqd", phi_q, kv)
        den = torch.einsum("bhqf,bhf->bhq", phi_q, z)[..., None] + 1e-6
        o = num / den
        return (lambda x, *d: x.permute(*d))(o, 0, 2, 1, 3).reshape(B, S, D) @ wo

    def _B_ref(x, w_r, w_gate, w_up, w_down):
        B, S, D = x.shape
        C = 2
        r = x @ w_r
        idx = torch.argsort(-r, axis=-1)[:, :C]
        idx_e = (lambda x, n, axis: torch.repeat_interleave(x, n, dim=axis))(idx.reshape(B, C, 1), D, axis=2)
        x_sel = (lambda x, i, axis: torch.take_along_dim(x, i, dim=axis))(x, idx_e, axis=1)
        g = _silu(x_sel @ w_gate)
        u = x_sel @ w_up
        y = (g * u) @ w_down
        r_sel = _sigmoid((lambda x, i, axis: torch.take_along_dim(x, i, dim=axis))(r, idx, axis=1))
        y = y * r_sel.reshape(B, C, 1)
        b_off = (torch.arange(B) * S).reshape(B, 1)
        flat_idx = (idx + b_off).reshape(B * C)
        zero = (x * 0.0).reshape(B * S, D)
        upd = _scatter_add(zero, flat_idx, y.reshape(B * C, D), axis=0)
        return x + upd.reshape(B, S, D)

    x = A_x
    xn = _layernorm(x, axis=-1)
    return x + _A_ref(xn, A_wqkv, A_w_phi, A_wo) + _B_ref(xn, B_w_r, B_w_gate, B_w_up, B_w_down)
```

```asm
; @launch grid=(256,1,1) block=(512,1,1) lds=163840
.amdgcn_target "amdgcn-amd-amdhsa--gfx950"
.text
.globl parallel_sum__linear_kernel_hedgehog__moe_arch_mod__prompt_kernel
.p2align 12
.p2align 8
.type parallel_sum__linear_kernel_hedgehog__moe_arch_mod__prompt_kernel,@function
parallel_sum__linear_kernel_hedgehog__moe_arch_mod__prompt_kernel:
    s_cmp_ge_u32 s2, 256
    s_cbranch_scc1 L_end
    s_load_dwordx2 s[8:9], s[0:1], 0
    s_load_dwordx2 s[12:13], s[0:1], 8
    s_load_dwordx2 s[16:17], s[0:1], 88
    s_load_dwordx2 s[32:33], s[0:1], 16
    s_load_dwordx2 s[20:21], s[0:1], 24
    s_load_dwordx2 s[24:25], s[0:1], 72
    s_load_dwordx2 s[28:29], s[0:1], 80
    v_lshrrev_b32 v1, 6, v0
    v_and_b32 v0, 63, v0
    s_lshr_b32 s6, s2, 3
    v_readfirstlane_b32 s4, v1
    s_and_b32 s5, s2, 7
    s_add_u32 s7, s6, 24
    s_and_b32 s7, s7, 31
    s_lshr_b32 s3, s6, 3
    s_or_b32 s3, s3, s4
    s_cmp_eq_u32 s3, 0
    s_cbranch_scc0 L_nopf
    s_getpc_b64 s[96:97]
L_pc:
    s_mul_i32 s3, s6, 5
    s_bfe_u32 s3, s3, 0x30003
    s_lshl_b32 s3, s3, 13
    v_lshl_add_u32 v2, v0, 7, s3
    v_min_u32 v2, L_end-L_pc, v2
    v_mov_b32 v3, s97
    v_add_co_u32 v2, vcc, s96, v2
    s_nop 1
    v_addc_co_u32 v3, vcc, 0, v3, vcc
    global_load_dword v255, v[2:3], off
L_nopf:
    s_mov_b32 s10, 2621440
    s_mov_b32 s11, 0x20000
    s_mov_b32 s14, 2457600
    s_mov_b32 s15, 0x20000
    s_cmp_ge_u32 s7, 24
    s_cbranch_scc1 L_helper
    s_lshr_b32 s54, s5, 2
    s_and_b32 s3, s7, 7
    s_lshl3_add_u32 s54, s54, s3
    s_lshr_b32 s53, s7, 3
    s_and_b32 s3, s5, 3
    s_lshl1_add_u32 s57, s3, s53
    s_add_u32 s3, s3, 8
    s_cmp_lt_u32 s7, 16
    s_cselect_b32 s57, s57, s3
    s_cmp_lt_u32 s4, 4
    s_cbranch_scc0 L_loader
    s_setprio 3
    s_mov_b32 s34, 25600
    s_mov_b32 s35, 0x20000
    s_lshr_b32 s59, s7, 2
    s_lshr_b32 s3, s7, 1
    s_sub_u32 s3, s3, 4
    s_cmp_lt_u32 s57, 8
    s_cselect_b32 s59, s59, s3
    s_and_b32 s3, s5, 3
    s_lshl3_add_u32 s59, s3, s59
    s_and_b32 s60, s4, 1
    s_lshl1_add_u32 s3, s57, s60
    s_mul_i32 s58, s3, 1600
    s_lshl_b32 s65, s4, 11
    s_mov_b32 m0, s65
    v_lshlrev_b32 v2, 4, v0
    v_lshlrev_b32 v3, 2, v0
    s_mul_i32 s59, s59, 800
    s_lshl_b32 s3, s4, 8
    s_add_u32 s59, s59, s3
    s_waitcnt lgkmcnt(0)
    buffer_load_dwordx4 v2, s[32:35], s58 offen lds
    buffer_load_dwordx4 v2, s[32:35], s58 offen offset:1024 lds
    s_add_u32 m0, s3, 151936
    s_cmp_eq_u32 s7, 16
    buffer_load_dword v3, s[32:35], s59 offen lds
    s_cbranch_scc0 L_mfma
    s_mov_b32 s18, 268435456
    s_mov_b32 s19, 0x20000
    v_mov_b32 v12, 0xff81ff81
    v_mov_b32 v13, 0xff81ff81
    v_mov_b32 v14, 0xff81ff81
    v_mov_b32 v15, 0xff81ff81
    s_lshl_b32 s3, s5, 13
    s_add_u32 s3, s3, s65
    buffer_store_dwordx4 v[12:15], v2, s[16:19], s3 offen offset:0 sc1
    buffer_store_dwordx4 v[12:15], v2, s[16:19], s3 offen offset:1024 sc1
    s_mov_b32 s30, 256
    s_mov_b32 s31, 0x20000
    s_lshr_b32 s3, s3, 8
    s_mov_b64 exec, 1
    s_waitcnt vmcnt(0)
    buffer_store_dword v12, off, s[28:31], s3 sc1
    s_mov_b64 exec, -1
    s_branch L_mfma
L_loader:
    s_setprio 2
    s_mul_i32 s55, s57, 160
    s_sub_u32 s59, s55, 2560
    s_cmp_lt_u32 s57, 8
    s_cselect_b32 s56, 1120, 0
    s_cselect_b32 s59, 1280, s59
    s_add_u32 s55, s55, s59
    s_sub_u32 s60, s4, 4
    v_lshrrev_b32 v8, 3, v0
    v_and_b32 v9, 7, v0
    v_bfe_u32 v10, v0, 4, 1
    v_lshrrev_b32 v11, 5, v0
    v_lshl_add_u32 v10, v10, 1, v11
    s_lshl2_add_u32 s3, s54, s60
    s_mul_i32 s3, s3, 40960
    v_mul_u32_u24 v8, 1280, v8
    v_xor_b32 v9, v9, v10
    v_add_u32 v8, s3, v8
    v_lshl_add_u32 v16, v9, 4, v8
    v_xor_b32 v11, 64, v16
    v_add_u32 v17, 9216, v11
    v_add_u32 v18, 18432, v16
    v_add_u32 v19, 27648, v11
    s_mul_i32 s3, s60, 61440
    s_add_u32 s3, s3, s55
    s_lshl_b32 s61, s60, 12
    s_mul_i32 s62, s60, 5152
    s_add_u32 s62, s62, 16384
    s_movk_i32 s63, 3520
    v_lshl_add_u32 v12, v0, 4, s3
    v_mul_u32_u24 v13, 6554, v0
    v_lshrrev_b32 v10, 17, v13
    v_bfe_u32 v9, v13, 16, 1
    v_mad_u32_u24 v8, v10, s63, v12
    v_mad_u32_u24 v20, v9, s56, v8
    v_add_u32 v13, 419456, v13
    v_lshrrev_b32 v10, 17, v13
    v_bfe_u32 v9, v13, 16, 1
    v_mad_u32_u24 v8, v10, s63, v12
    v_mad_u32_u24 v21, v9, s56, v8
    v_add_u32 v13, 419456, v13
    v_lshrrev_b32 v10, 17, v13
    v_bfe_u32 v9, v13, 16, 1
    v_mad_u32_u24 v8, v10, s63, v12
    v_mad_u32_u24 v22, v9, s56, v8
    v_add_u32 v13, 419456, v13
    v_lshrrev_b32 v10, 17, v13
    v_bfe_u32 v9, v13, 16, 1
    v_mad_u32_u24 v8, v10, s63, v12
    v_mad_u32_u24 v23, v9, s56, v8
    v_add_u32 v13, 419456, v13
    v_lshrrev_b32 v10, 17, v13
    v_bfe_u32 v9, v13, 16, 1
    v_mad_u32_u24 v8, v10, s63, v12
    v_mad_u32_u24 v24, v9, s56, v8
    v_add_u32 v24, 4096, v24
    s_lshl_b32 s53, s53, 1
    s_lshr_b32 s53, 28, s53
    s_xor_b32 s71, s7, s53
    s_bfe_u32 s63, s71, 0x10001
    s_and_b32 s71, s71, 1
    s_waitcnt lgkmcnt(0)
    s_xor_b32 s66, s71, 0
    s_add_u32 m0, s61, 40960
    s_lshl_b32 s65, s66, 7
    s_mul_i32 s66, s66, 245760
    s_cmp_eq_u32 s63, 0
    s_cbranch_scc0 L_rv0
    buffer_load_dwordx4 v16, s[8:11], s65 offen offset:0 lds
    buffer_load_dwordx4 v17, s[8:11], s65 offen offset:1024 lds
    buffer_load_dwordx4 v18, s[8:11], s65 offen offset:2048 lds
    buffer_load_dwordx4 v19, s[8:11], s65 offen offset:3072 lds
    s_add_u32 m0, s62, 40960
    s_nop 0
    buffer_load_dwordx4 v20, s[12:15], s66 offen offset:0 lds
    buffer_load_dwordx4 v21, s[12:15], s66 offen offset:1024 lds
    buffer_load_dwordx4 v22, s[12:15], s66 offen offset:2048 lds
    buffer_load_dwordx4 v23, s[12:15], s66 offen offset:3072 lds
    s_add_u32 m0, m0, 4096
    s_nop 0
    buffer_load_dwordx4 v24, s[12:15], s66 offen offset:0 lds
    s_branch L_re0
L_rv0:
    s_add_u32 m0, s62, 45056
    s_nop 0
    buffer_load_dwordx4 v24, s[12:15], s66 offen offset:0 lds
    s_add_u32 m0, s62, 40960
    s_nop 0
    buffer_load_dwordx4 v23, s[12:15], s66 offen offset:3072 lds
    buffer_load_dwordx4 v22, s[12:15], s66 offen offset:2048 lds
    buffer_load_dwordx4 v21, s[12:15], s66 offen offset:1024 lds
    buffer_load_dwordx4 v20, s[12:15], s66 offen offset:0 lds
    s_add_u32 m0, s61, 40960
    s_nop 0
    buffer_load_dwordx4 v19, s[8:11], s65 offen offset:3072 lds
    buffer_load_dwordx4 v18, s[8:11], s65 offen offset:2048 lds
    buffer_load_dwordx4 v17, s[8:11], s65 offen offset:1024 lds
    buffer_load_dwordx4 v16, s[8:11], s65 offen offset:0 lds
L_re0:
    s_lshr_b32 s36, s7, 2
    s_lshr_b32 s3, s7, 1
    s_sub_u32 s3, s3, 4
    s_cmp_lt_u32 s57, 8
    s_cselect_b32 s36, s36, s3
    s_and_b32 s3, s5, 3
    s_lshl3_add_u32 s36, s3, s36
    s_lshl_b32 s3, s7, 1
    s_cmp_lt_u32 s57, 8
    s_cselect_b32 s3, s7, s3
    s_and_b32 s3, s3, 3
    s_and_b32 s37, s5, 4
    s_add_u32 s37, s37, s3
    s_lshl3_add_u32 s37, s37, s4
    s_lshl_b32 s3, s36, 6
    s_add_u32 s3, s3, s37
    s_mul_i32 s38, s3, 1280
    s_add_u32 s38, s38, 65536
    s_and_b32 s39, s37, 60
    s_lshr_b32 s3, s36, 3
    s_add_u32 s39, s39, s3
    s_lshl_b32 s39, s39, 7
    s_add_u32 s39, s39, 45056
    s_and_b32 s3, s37, 2
    s_lshl3_add_u32 s39, s3, s39
    s_and_b32 s3, s36, 6
    s_lshl1_add_u32 s39, s3, s39
    s_mul_i32 s40, s36, 28672
    s_add_u32 s40, s40, 2924544
    s_mul_i32 s41, s37, 40960
    s_add_u32 s41, s41, 4259840
    s_lshl_b32 s3, s36, 7
    s_add_u32 s42, s41, s3
    s_add_u32 s42, s42, 16384
    s_lshl2_add_u32 s41, s3, s41
    s_lshr_b32 s3, s5, 2
    s_and_b32 s44, s7, 1
    s_lshl1_add_u32 s44, s3, s44
    s_and_b32 s3, s36, 28
    s_add_u32 s3, s3, s44
    s_lshl_b32 s3, s3, 7
    s_add_u32 s44, s3, 53248
    v_and_b32 v43, 31, v0
    v_lshlrev_b32 v43, 3, v43
    s_lshr_b32 s3, s37, 3
    s_and_b32 s53, s36, 1
    s_lshl1_add_u32 s3, s3, s53
    s_lshl_b32 s3, s3, 9
    s_add_u32 s43, s3, 57344
    v_mul_u32_u24 v98, 6554, v0
    v_lshlrev_b32 v97, 4, v0
    s_movk_i32 s3, 1120
    v_lshrrev_b32 v96, 16, v98
    v_mad_u32_u24 v224, v96, s3, v97
    v_add_u32 v98, 419456, v98
    v_lshrrev_b32 v96, 16, v98
    v_mad_u32_u24 v225, v96, s3, v97
    v_add_u32 v98, 419456, v98
    v_lshrrev_b32 v96, 16, v98
    v_mad_u32_u24 v226, v96, s3, v97
    v_add_u32 v98, 419456, v98
    v_lshrrev_b32 v96, 16, v98
    v_mad_u32_u24 v227, v96, s3, v97
    v_add_u32 v98, 419456, v98
    v_lshrrev_b32 v96, 16, v98
    v_mad_u32_u24 v228, v96, s3, v97
    v_add_u32 v228, 4096, v228
    s_and_b32 s67, s6, 7
    s_mul_i32 s67, s67, 160
    s_mul_i32 s68, s60, 40960
    s_add_u32 s68, s68, s67
    s_mul_i32 s69, s60, 5120
    s_lshr_b32 s3, s6, 3
    s_lshl2_add_u32 s3, s5, s3
    s_mul_i32 s67, s3, 81920
    s_add_u32 s67, s67, s68
    s_bfe_u32 s3, s6, 0x10003
    s_mul_i32 s98, s3, 163840
    s_add_u32 s96, s68, s98
    s_sub_u32 s98, s68, s98
    s_mul_i32 s99, s3, 20480
    s_add_u32 s97, s69, s99
    s_sub_u32 s99, s69, s99
    v_and_b32 v56, 31, v0
    s_lshl2_add_u32 s3, s54, s60
    s_lshl_b32 s3, s3, 7
    s_add_u32 s3, s3, 8192
    v_lshl_add_u32 v57, v56, 2, s3
    s_lshr_b32 s58, s60, 1
    s_and_b32 s59, s60, 1
    s_add_u32 s3, s56, 160
    s_mul_i32 s3, s3, s58
    s_add_u32 s3, s3, s55
    s_lshl_b32 s3, s3, 1
    s_mul_i32 s53, s59, 7680
    s_add_u32 s3, s3, s53
    s_add_u32 s3, s3, 16384
    v_min_u32 v59, 39, v0
    v_lshl_add_u32 v58, v59, 3, s3
    s_lshl_b32 s3, s60, 9
    s_add_u32 s3, s3, 152960
    v_lshl_add_u32 v56, v56, 4, s3
    s_mul_i32 s3, s59, 640
    s_mul_i32 s53, s58, 320
    s_add_u32 s3, s3, s53
    s_add_u32 s3, s3, 155008
    v_lshl_add_u32 v68, v59, 3, s3
    s_mul_i32 s3, s60, 160
    s_add_u32 s3, s3, 156288
    v_lshl_add_u32 v69, v59, 2, s3
    v_mov_b32 v61, 0
    ds_write_b32 v69, v61
    s_xor_b32 s66, s71, 1
    s_add_u32 m0, s61, 77952
    s_lshl_b32 s65, s66, 7
    s_mul_i32 s66, s66, 245760
    s_mov_b32 s18, 268435456
    s_mov_b32 s19, 0x20000
    s_mov_b32 s34, 25600
    s_mov_b32 s35, 0x20000
    s_mov_b32 s22, 819200
    s_mov_b32 s23, 0x20000
    s_mov_b32 s26, 2621440
    s_mov_b32 s27, 0x20000
    buffer_load_dwordx4 v16, s[8:11], s65 offen offset:0 lds
    s_mov_b32 s30, 256
    s_mov_b32 s31, 0x20000
    s_mov_b32 s52, 0xff81ff81
    v_lshrrev_b32 v3, 4, v0
    v_bfe_u32 v4, v0, 2, 2
    v_and_b32 v5, 3, v0
    v_and_b32 v6, 15, v0
    s_lshr_b32 s64, s60, 1
    buffer_load_dwordx4 v17, s[8:11], s65 offen offset:1024 lds
    s_and_b32 s53, s60, 1
    v_and_b32 v7, 1, v0
    v_bfe_u32 v12, v0, 1, 1
    v_lshl_or_b32 v7, v12, 2, v7
    v_bfe_u32 v12, v0, 2, 1
    v_lshl_or_b32 v7, v12, 1, v7
    v_lshlrev_b32 v7, 4, v7
    buffer_load_dwordx4 v18, s[8:11], s65 offen offset:2048 lds
    s_lshl_b32 s3, s64, 13
    s_add_u32 s3, s3, 86016
    v_lshl_add_u32 v7, v6, 7, v7
    v_add_u32 v7, s3, v7
    s_lshl_b32 s58, s53, 15
    v_lshrrev_b32 v12, 1, v3
    v_and_b32 v13, 1, v3
    v_lshl_add_u32 v14, v12, 14, v7
    buffer_load_dwordx4 v19, s[8:11], s65 offen offset:3072 lds
    s_add_u32 m0, s62, 77952
    v_add_u32 v14, s58, v14
    v_lshlrev_b32 v15, 5, v13
    v_xor_b32 v240, v14, v15
    v_xor_b32 v241, 16, v240
    v_xor_b32 v242, 96, v14
    v_lshl_add_u32 v242, v13, 3, v242
    s_lshl_b32 s3, s64, 10
    buffer_load_dwordx4 v20, s[12:15], s66 offen offset:0 lds
    s_add_u32 s3, s3, 152960
    v_lshl_add_u32 v206, v6, 4, s3
    s_lshl_b32 s64, s60, 11
    v_lshrrev_b32 v7, 1, v5
    v_mul_u32_u24 v12, 640, v7
    v_lshl_add_u32 v13, v3, 2, v4
    v_mul_u32_u24 v13, 40, v13
    v_add3_u32 v12, v12, v13, s64
    buffer_load_dwordx4 v21, s[12:15], s66 offen offset:1024 lds
    v_mul_u32_u24 v13, 1440, v7
    v_mul_u32_u24 v14, 40, v4
    v_add3_u32 v13, v13, v14, s64
    v_bfe_u32 v7, v0, 3, 1
    v_add_u32 v14, -1, v7
    v_not_b32 v15, v14
    v_cmp_eq_u32 vcc, v7, v3
    buffer_load_dwordx4 v22, s[12:15], s66 offen offset:2048 lds
    v_bfe_i32 v2, v0, 2, 1
    v_and_b32 v2, 0x80008000, v2
    v_cndmask_b32 v7, 0, -1, vcc
    s_getreg_b32 s64, hwreg(HW_REG_XCC_ID)
    s_lshl_b32 s70, s5, 9
    s_add_u32 s70, s70, 40960
    v_mov_b32 v44, s64
    s_and_b32 s3, s7, 3
    buffer_load_dwordx4 v23, s[12:15], s66 offen offset:3072 lds
    s_add_u32 m0, m0, 4096
    s_mul_i32 s3, s3, 127
    s_add_u32 s3, s3, s7
    s_add_u32 s49, s3, s70
    v_min_u32 v45, 23, v0
    v_and_b32 v46, 3, v45
    v_mul_u32_u24 v46, 127, v46
    v_add_u32 v45, v45, v46
    buffer_load_dwordx4 v24, s[12:15], s66 offen offset:0 lds
    s_setprio 0
    s_waitcnt vmcnt(9)
    s_barrier
    s_xor_b32 s66, s71, 2
    s_add_u32 m0, s61, 114944
    s_lshl_b32 s65, s66, 7
    s_mul_i32 s66, s66, 245760
    s_cmp_eq_u32 s63, 0
    s_cbranch_scc0 L_rv2
    buffer_load_dwordx4 v16, s[8:11], s65 offen offset:0 lds
    buffer_load_dwordx4 v17, s[8:11], s65 offen offset:1024 lds
    buffer_load_dwordx4 v18, s[8:11], s65 offen offset:2048 lds
    buffer_load_dwordx4 v19, s[8:11], s65 offen offset:3072 lds
    s_add_u32 m0, s62, 114944
    s_nop 0
    buffer_load_dwordx4 v20, s[12:15], s66 offen offset:0 lds
    buffer_load_dwordx4 v21, s[12:15], s66 offen offset:1024 lds
    buffer_load_dwordx4 v22, s[12:15], s66 offen offset:2048 lds
    buffer_load_dwordx4 v23, s[12:15], s66 offen offset:3072 lds
    s_add_u32 m0, m0, 4096
    s_nop 0
    buffer_load_dwordx4 v24, s[12:15], s66 offen offset:0 lds
    s_branch L_re2
L_rv2:
    s_add_u32 m0, s62, 119040
    s_nop 0
    buffer_load_dwordx4 v24, s[12:15], s66 offen offset:0 lds
    s_add_u32 m0, s62, 114944
    s_nop 0
    buffer_load_dwordx4 v23, s[12:15], s66 offen offset:3072 lds
    buffer_load_dwordx4 v22, s[12:15], s66 offen offset:2048 lds
    buffer_load_dwordx4 v21, s[12:15], s66 offen offset:1024 lds
    buffer_load_dwordx4 v20, s[12:15], s66 offen offset:0 lds
    s_add_u32 m0, s61, 114944
    s_nop 0
    buffer_load_dwordx4 v19, s[8:11], s65 offen offset:3072 lds
    buffer_load_dwordx4 v18, s[8:11], s65 offen offset:2048 lds
    buffer_load_dwordx4 v17, s[8:11], s65 offen offset:1024 lds
    buffer_load_dwordx4 v16, s[8:11], s65 offen offset:0 lds
L_re2:
    s_waitcnt vmcnt(9)
    s_barrier
    s_xor_b32 s66, s71, 3
    s_add_u32 m0, s61, 40960
    s_lshl_b32 s65, s66, 7
    s_mul_i32 s66, s66, 245760
    s_cmp_lt_u32 s57, 8
    s_cbranch_scc0 L_ko_1
    ds_read_b64_tr_b16 v[176:177], v12 offset:160
    ds_read_b64_tr_b16 v[196:197], v13 offset:0
    ds_read_b64_tr_b16 v[180:181], v12 offset:168
    ds_read_b64_tr_b16 v[198:199], v13 offset:8
    ds_read_b64_tr_b16 v[184:185], v12 offset:176
L_ko_1:
    s_cmp_lt_u32 s57, 8
    s_cbranch_scc0 L_ko_2
    ds_read_b64_tr_b16 v[200:201], v13 offset:16
    ds_read_b64_tr_b16 v[188:189], v12 offset:184
    ds_read_b64_tr_b16 v[202:203], v13 offset:24
    ds_read_b64_tr_b16 v[192:193], v12 offset:192
    ds_read_b64_tr_b16 v[204:205], v13 offset:32
L_ko_2:
    buffer_load_dwordx4 v16, s[8:11], s65 offen offset:0 lds
    s_cmp_lt_u32 s57, 8
    s_cbranch_scc0 L_ko_3
    s_waitcnt lgkmcnt(0)
    v_bitop3_b32 v178, v176, v2, v15 bitop3:0x28
    v_bitop3_b32 v176, v176, v2, v14 bitop3:0x28
    v_bitop3_b32 v196, v196, v2, v7 bitop3:0x28
    v_bitop3_b32 v179, v177, v2, v15 bitop3:0x28
L_ko_3:
    buffer_load_dwordx4 v17, s[8:11], s65 offen offset:1024 lds
    s_cmp_lt_u32 s57, 8
    s_cbranch_scc0 L_ko_4
    v_bitop3_b32 v177, v177, v2, v14 bitop3:0x28
    v_bitop3_b32 v197, v197, v2, v7 bitop3:0x28
    v_bitop3_b32 v182, v180, v2, v15 bitop3:0x28
    v_bitop3_b32 v180, v180, v2, v14 bitop3:0x28
    v_bitop3_b32 v198, v198, v2, v7 bitop3:0x28
L_ko_4:
    buffer_load_dwordx4 v18, s[8:11], s65 offen offset:2048 lds
    s_cmp_lt_u32 s57, 8
    s_cbranch_scc0 L_ko_5
    v_bitop3_b32 v183, v181, v2, v15 bitop3:0x28
    v_bitop3_b32 v181, v181, v2, v14 bitop3:0x28
    v_bitop3_b32 v199, v199, v2, v7 bitop3:0x28
    v_bitop3_b32 v186, v184, v2, v15 bitop3:0x28
    v_bitop3_b32 v184, v184, v2, v14 bitop3:0x28
L_ko_5:
    buffer_load_dwordx4 v19, s[8:11], s65 offen offset:3072 lds
    s_add_u32 m0, s62, 40960
    s_cmp_lt_u32 s57, 8
    s_cbranch_scc0 L_ko_6
    v_bitop3_b32 v200, v200, v2, v7 bitop3:0x28
    v_bitop3_b32 v187, v185, v2, v15 bitop3:0x28
    v_bitop3_b32 v185, v185, v2, v14 bitop3:0x28
    v_bitop3_b32 v201, v201, v2, v7 bitop3:0x28
    v_bitop3_b32 v190, v188, v2, v15 bitop3:0x28
L_ko_6:
    s_cmp_lt_u32 s57, 8
    s_cbranch_scc0 L_ko_7
    v_bitop3_b32 v188, v188, v2, v14 bitop3:0x28
    v_bitop3_b32 v202, v202, v2, v7 bitop3:0x28
    v_bitop3_b32 v191, v189, v2, v15 bitop3:0x28
    v_bitop3_b32 v189, v189, v2, v14 bitop3:0x28
    v_bitop3_b32 v203, v203, v2, v7 bitop3:0x28
L_ko_7:
    buffer_load_dwordx4 v20, s[12:15], s66 offen offset:0 lds
    s_cmp_lt_u32 s57, 8
    s_cbranch_scc0 L_ko_8
    v_bitop3_b32 v194, v192, v2, v15 bitop3:0x28
    v_bitop3_b32 v192, v192, v2, v14 bitop3:0x28
    v_bitop3_b32 v204, v204, v2, v7 bitop3:0x28
    v_bitop3_b32 v195, v193, v2, v15 bitop3:0x28
    v_bitop3_b32 v193, v193, v2, v14 bitop3:0x28
L_ko_8:
    buffer_load_dwordx4 v21, s[12:15], s66 offen offset:1024 lds
    s_cmp_lt_u32 s57, 8
    s_cbranch_scc0 L_ko_9
    v_bitop3_b32 v205, v205, v2, v7 bitop3:0x28
L_ko_9:
    v_lshlrev_b32 v7, 4, v0
    buffer_load_dwordx4 v22, s[12:15], s66 offen offset:2048 lds
    v_and_b32 v96, 31, v0
    v_lshlrev_b32 v1, 3, v96
    s_lshl_b32 s3, s37, 7
    s_add_u32 s3, s3, 8192
    v_lshl_add_u32 v255, v96, 2, s3
    v_mov_b32 v98, 0x7ff00000
    v_mov_b32 v253, 0
    s_lshl_b32 s3, s4, 4
    v_and_b32 v14, 15, v0
    v_add_u32 v14, s3, v14
    buffer_load_dwordx4 v23, s[12:15], s66 offen offset:3072 lds
    s_add_u32 m0, m0, 4096
    v_cmp_lt_u32 vcc, 104, v14
    v_lshlrev_b32 v14, 4, v14
    v_lshrrev_b32 v99, 4, v0
    v_mul_u32_u24 v15, 7168, v99
    v_add_u32 v15, v15, v14
    v_cndmask_b32 v15, v15, v98, vcc
    v_and_b32 v99, 1, v99
    v_lshl_add_u32 v14, v99, 3, v14
    v_add_u32 v14, 156928, v14
    buffer_load_dwordx4 v24, s[12:15], s66 offen offset:0 lds
    s_waitcnt vmcnt(9)
    s_barrier
    buffer_load_dword v42, v43, s[28:31], 0 offen sc1
    s_xor_b32 s66, s71, 4
    s_add_u32 m0, s61, 77952
    s_lshl_b32 s65, s66, 7
    s_mul_i32 s66, s66, 245760
    s_cmp_eq_u32 s63, 0
    s_cbranch_scc0 L_rv4
    buffer_load_dwordx4 v16, s[8:11], s65 offen offset:0 lds
    buffer_load_dwordx4 v17, s[8:11], s65 offen offset:1024 lds
    buffer_load_dwordx4 v18, s[8:11], s65 offen offset:2048 lds
    buffer_load_dwordx4 v19, s[8:11], s65 offen offset:3072 lds
    s_add_u32 m0, s62, 77952
    s_nop 0
    buffer_load_dwordx4 v20, s[12:15], s66 offen offset:0 lds
    buffer_load_dwordx4 v21, s[12:15], s66 offen offset:1024 lds
    buffer_load_dwordx4 v22, s[12:15], s66 offen offset:2048 lds
    buffer_load_dwordx4 v23, s[12:15], s66 offen offset:3072 lds
    s_add_u32 m0, m0, 4096
    s_nop 0
    buffer_load_dwordx4 v24, s[12:15], s66 offen offset:0 lds
    s_branch L_re4
L_rv4:
    s_add_u32 m0, s62, 82048
    s_nop 0
    buffer_load_dwordx4 v24, s[12:15], s66 offen offset:0 lds
    s_add_u32 m0, s62, 77952
    s_nop 0
    buffer_load_dwordx4 v23, s[12:15], s66 offen offset:3072 lds
    buffer_load_dwordx4 v22, s[12:15], s66 offen offset:2048 lds
    buffer_load_dwordx4 v21, s[12:15], s66 offen offset:1024 lds
    buffer_load_dwordx4 v20, s[12:15], s66 offen offset:0 lds
    s_add_u32 m0, s61, 77952
    s_nop 0
    buffer_load_dwordx4 v19, s[8:11], s65 offen offset:3072 lds
    buffer_load_dwordx4 v18, s[8:11], s65 offen offset:2048 lds
    buffer_load_dwordx4 v17, s[8:11], s65 offen offset:1024 lds
    buffer_load_dwordx4 v16, s[8:11], s65 offen offset:0 lds
L_re4:
    s_waitcnt vmcnt(10)
    s_barrier
    s_xor_b32 s66, s71, 5
    s_add_u32 m0, s61, 114944
    s_lshl_b32 s65, s66, 7
    s_mul_i32 s66, s66, 245760
    v_lshrrev_b32 v96, 5, v0
    v_bfe_u32 v97, v0, 2, 2
    v_bfe_u32 v98, v0, 4, 1
    v_bfe_u32 v99, v0, 1, 1
    v_lshl_add_u32 v98, v98, 1, v99
    buffer_load_dwordx4 v16, s[8:11], s65 offen offset:0 lds
    s_bitcmp0_b32 s36, 0
    s_cselect_b32 s3, 160, 0
    s_cselect_b32 s53, 0, 640
    s_add_u32 s3, s3, 151936
    s_add_u32 s53, s53, 151936
    buffer_load_dwordx4 v17, s[8:11], s65 offen offset:1024 lds
    v_mul_u32_u24 v99, 40, v97
    v_add_u32 v100, s53, v99
    v_mul_u32_u24 v101, 320, v96
    v_add3_u32 v99, v99, v101, s3
    v_lshl_add_u32 v101, v98, 3, v99
    buffer_load_dwordx4 v18, s[8:11], s65 offen offset:2048 lds
    v_lshl_add_u32 v98, v98, 3, v100
    ds_read_b64_tr_b16 v[28:29], v101
    ds_read_b64_tr_b16 v[30:31], v101 offset:160
    ds_read_b64_tr_b16 v[32:33], v99 offset:32
    ds_read_b64_tr_b16 v[34:35], v99 offset:192
    buffer_load_dwordx4 v19, s[8:11], s65 offen offset:3072 lds
    s_add_u32 m0, s62, 114944
    ds_read_b64_tr_b16 v[36:37], v98
    ds_read_b64_tr_b16 v[38:39], v100 offset:32
    v_bfe_i32 v102, v0, 2, 1
    v_and_b32 v102, 0x80008000, v102
    v_add_u32 v103, -1, v96
    buffer_load_dwordx4 v20, s[12:15], s66 offen offset:0 lds
    v_add_u32 v104, 158976, v7
    s_waitcnt lgkmcnt(0)
    v_xor_b32 v28, v102, v28
    v_xor_b32 v29, v102, v29
    v_xor_b32 v30, v102, v30
    buffer_load_dwordx4 v21, s[12:15], s66 offen offset:1024 lds
    v_xor_b32 v31, v102, v31
    v_xor_b32 v32, v102, v32
    v_xor_b32 v33, v102, v33
    v_xor_b32 v34, v102, v34
    v_xor_b32 v35, v102, v35
    buffer_load_dwordx4 v22, s[12:15], s66 offen offset:2048 lds
    v_bitop3_b32 v36, v36, v102, v103 bitop3:0x28
    v_bitop3_b32 v37, v37, v102, v103 bitop3:0x28
    v_bitop3_b32 v38, v38, v102, v103 bitop3:0x28
    v_bitop3_b32 v39, v39, v102, v103 bitop3:0x28
    s_cmp_eq_u32 s60, 0
    s_cbranch_scc0 L_oa
    ds_write_b128 v104, v[28:31] offset:0
    ds_write_b128 v104, v[32:35] offset:1024
    ds_write_b128 v104, v[36:39] offset:2048
L_oa:
    buffer_load_dwordx4 v23, s[12:15], s66 offen offset:3072 lds
    s_add_u32 m0, m0, 4096
    s_nop 0
    buffer_load_dwordx4 v24, s[12:15], s66 offen offset:0 lds
    s_waitcnt vmcnt(9)
    s_barrier
    s_xor_b32 s66, s71, 6
    s_add_u32 m0, s61, 40960
    s_lshl_b32 s65, s66, 7
    s_mul_i32 s66, s66, 245760
    s_cmp_eq_u32 s63, 0
    s_cbranch_scc0 L_rv6
    buffer_load_dwordx4 v16, s[8:11], s65 offen offset:0 lds
    buffer_load_dwordx4 v17, s[8:11], s65 offen offset:1024 lds
    buffer_load_dwordx4 v18, s[8:11], s65 offen offset:2048 lds
    buffer_load_dwordx4 v19, s[8:11], s65 offen offset:3072 lds
    s_add_u32 m0, s62, 40960
    s_nop 0
    buffer_load_dwordx4 v20, s[12:15], s66 offen offset:0 lds
    buffer_load_dwordx4 v21, s[12:15], s66 offen offset:1024 lds
    buffer_load_dwordx4 v22, s[12:15], s66 offen offset:2048 lds
    buffer_load_dwordx4 v23, s[12:15], s66 offen offset:3072 lds
    s_add_u32 m0, m0, 4096
    s_nop 0
    buffer_load_dwordx4 v24, s[12:15], s66 offen offset:0 lds
    s_branch L_re6
L_rv6:
    s_add_u32 m0, s62, 45056
    s_nop 0
    buffer_load_dwordx4 v24, s[12:15], s66 offen offset:0 lds
    s_add_u32 m0, s62, 40960
    s_nop 0
    buffer_load_dwordx4 v23, s[12:15], s66 offen offset:3072 lds
    buffer_load_dwordx4 v22, s[12:15], s66 offen offset:2048 lds
    buffer_load_dwordx4 v21, s[12:15], s66 offen offset:1024 lds
    buffer_load_dwordx4 v20, s[12:15], s66 offen offset:0 lds
    s_add_u32 m0, s61, 40960
    s_nop 0
    buffer_load_dwordx4 v19, s[8:11], s65 offen offset:3072 lds
    buffer_load_dwordx4 v18, s[8:11], s65 offen offset:2048 lds
    buffer_load_dwordx4 v17, s[8:11], s65 offen offset:1024 lds
    buffer_load_dwordx4 v16, s[8:11], s65 offen offset:0 lds
L_re6:
    v_cmp_eq_u32 vcc, 0, v42
    s_cbranch_vccnz L_rlate
L_rret:
    s_cmp_eq_u32 s60, 0
    s_cbranch_scc0 L_xid
    s_mov_b64 exec, 1
    buffer_store_dword v44, off, s[16:19], s49 sc1
    s_mov_b64 exec, -1
L_xid:
    s_waitcnt vmcnt(9)
    s_barrier
    s_xor_b32 s66, s71, 7
    s_add_u32 m0, s61, 77952
    s_lshl_b32 s65, s66, 7
    s_mul_i32 s66, s66, 245760
    buffer_load_dwordx4 v16, s[8:11], s65 offen offset:0 lds
    buffer_load_dwordx4 v17, s[8:11], s65 offen offset:1024 lds
    buffer_load_dwordx4 v18, s[8:11], s65 offen offset:2048 lds
    buffer_load_dwordx4 v19, s[8:11], s65 offen offset:3072 lds
    s_add_u32 m0, s62, 77952
    s_nop 0
    buffer_load_dwordx4 v20, s[12:15], s66 offen offset:0 lds
    buffer_load_dwordx4 v21, s[12:15], s66 offen offset:1024 lds
    buffer_load_dwordx4 v22, s[12:15], s66 offen offset:2048 lds
    buffer_load_dwordx4 v23, s[12:15], s66 offen offset:3072 lds
    s_add_u32 m0, m0, 4096
    s_nop 0
    buffer_load_dwordx4 v24, s[12:15], s66 offen offset:0 lds
    s_waitcnt vmcnt(9)
    s_barrier
    s_xor_b32 s66, s71, 8
    s_add_u32 m0, s61, 114944
    s_lshl_b32 s65, s66, 7
    s_mul_i32 s66, s66, 245760
    s_cmp_eq_u32 s63, 0
    s_cbranch_scc0 L_rv8
    buffer_load_dwordx4 v16, s[8:11], s65 offen offset:0 lds
    buffer_load_dwordx4 v17, s[8:11], s65 offen offset:1024 lds
    buffer_load_dwordx4 v18, s[8:11], s65 offen offset:2048 lds
    buffer_load_dwordx4 v19, s[8:11], s65 offen offset:3072 lds
    s_add_u32 m0, s62, 114944
    s_nop 0
    buffer_load_dwordx4 v20, s[12:15], s66 offen offset:0 lds
    buffer_load_dwordx4 v21, s[12:15], s66 offen offset:1024 lds
    buffer_load_dwordx4 v22, s[12:15], s66 offen offset:2048 lds
    buffer_load_dwordx4 v23, s[12:15], s66 offen offset:3072 lds
    s_add_u32 m0, m0, 4096
    s_nop 0
    buffer_load_dwordx4 v24, s[12:15], s66 offen offset:0 lds
    s_branch L_re8
L_rv8:
    s_add_u32 m0, s62, 119040
    s_nop 0
    buffer_load_dwordx4 v24, s[12:15], s66 offen offset:0 lds
    s_add_u32 m0, s62, 114944
    s_nop 0
    buffer_load_dwordx4 v23, s[12:15], s66 offen offset:3072 lds
    buffer_load_dwordx4 v22, s[12:15], s66 offen offset:2048 lds
    buffer_load_dwordx4 v21, s[12:15], s66 offen offset:1024 lds
    buffer_load_dwordx4 v20, s[12:15], s66 offen offset:0 lds
    s_add_u32 m0, s61, 114944
    s_nop 0
    buffer_load_dwordx4 v19, s[8:11], s65 offen offset:3072 lds
    buffer_load_dwordx4 v18, s[8:11], s65 offen offset:2048 lds
    buffer_load_dwordx4 v17, s[8:11], s65 offen offset:1024 lds
    buffer_load_dwordx4 v16, s[8:11], s65 offen offset:0 lds
L_re8:
    s_waitcnt vmcnt(9)
    s_barrier
    s_xor_b32 s66, s71, 9
    s_add_u32 m0, s61, 40960
    s_lshl_b32 s65, s66, 7
    s_mul_i32 s66, s66, 245760
    buffer_load_dwordx4 v16, s[8:11], s65 offen offset:0 lds
    buffer_load_dwordx4 v17, s[8:11], s65 offen offset:1024 lds
    buffer_load_dwordx4 v18, s[8:11], s65 offen offset:2048 lds
    buffer_load_dwordx4 v19, s[8:11], s65 offen offset:3072 lds
    s_add_u32 m0, s62, 40960
    s_nop 0
    buffer_load_dwordx4 v20, s[12:15], s66 offen offset:0 lds
    buffer_load_dwordx4 v21, s[12:15], s66 offen offset:1024 lds
    buffer_load_dwordx4 v22, s[12:15], s66 offen offset:2048 lds
    buffer_load_dwordx4 v23, s[12:15], s66 offen offset:3072 lds
    s_add_u32 m0, m0, 4096
    s_nop 0
    buffer_load_dwordx4 v24, s[12:15], s66 offen offset:0 lds
    s_waitcnt vmcnt(9)
    s_barrier
    s_cmp_lt_u32 s57, 8
    s_cbranch_scc1 L_nx
    s_cmp_eq_u32 s60, 0
    s_cbranch_scc0 L_nx
    buffer_load_dword v44, v45, s[16:19], s70 offen sc1
L_nx:
    buffer_load_dword v60, v57, s[16:19], 0 offen sc1
    buffer_load_dwordx2 v[62:63], v58, s[16:19], 0 offen sc1
    s_cmp_lt_u32 s57, 8
    s_cbranch_scc1 L_r0
    s_sub_u32 s3, s57, 8
    s_lshl2_add_u32 s3, s3, s60
    s_mul_i32 s58, s3, 163840
    s_mul_i32 s3, s54, 5120
    s_add_u32 s58, s58, s3
    s_add_u32 s58, s58, 65536
    s_add_u32 s59, s58, 81920
    v_lshlrev_b32 v47, 7, v0
    s_mov_b32 exec_hi, 0xff
    buffer_load_dword v48, v47, s[16:19], s58 offen
    buffer_load_dword v48, v47, s[16:19], s59 offen
    s_mov_b32 exec_hi, -1
    s_mov_b64 exec, 1
    buffer_load_dword v253, off, s[16:19], s39 sc1
    s_mov_b64 exec, -1
    s_waitcnt vmcnt(3)
    s_branch L_r0d
L_r0:
    s_add_u32 m0, s97, 0
    s_add_u32 s65, s96, 0
    buffer_load_dwordx4 v224, s[20:23], s65 offen offset:0 lds
    buffer_load_dwordx4 v225, s[20:23], s65 offen offset:1024 lds
    buffer_load_dwordx4 v226, s[20:23], s65 offen offset:2048 lds
    buffer_load_dwordx4 v227, s[20:23], s65 offen offset:3072 lds
    s_add_u32 m0, m0, 4096
    s_nop 0
    buffer_load_dwordx4 v228, s[20:23], s65 offen lds
L_r0d:
    s_waitcnt vmcnt(5)
    s_barrier
    v_max3_u32 v41, v60, v62, v63
    v_cmp_eq_u32 vcc, s52, v41
    s_cbranch_vccz L_ok_10
    s_mov_b32 s3, 0
L_poll_11:
    s_add_u32 s3, s3, 1
    s_cmp_gt_u32 s3, 200000
    s_cbranch_scc1 L_pdone_13
    buffer_load_dword v60, v57, s[16:19], 0 offen sc1
    buffer_load_dwordx2 v[62:63], v58, s[16:19], 0 offen sc1
L_chk_12:
    s_waitcnt vmcnt(0)
    v_max3_u32 v41, v60, v62, v63
    v_cmp_eq_u32 vcc, s52, v41
    s_cbranch_vccnz L_poll_11
L_pdone_13:
L_ok_10:
    ds_write_b64 v68, v[62:63]
    v_and_b32 v66, 0xffff0000, v60
    v_rcp_f32 v66, v66
    v_and_b32 v64, 0xffff, v60
    v_lshl_or_b32 v64, v64, 16, v64
    v_xor_b32 v64, 0x80008000, v64
    v_lshrrev_b32 v65, 16, v60
    v_mul_f32 v67, 0x3fb8aa3b, v66
    ds_write_b128 v56, v[64:67]
    s_cmp_lt_u32 s57, 8
    s_cbranch_scc0 L_lq
    s_add_u32 m0, s99, 20480
    s_add_u32 s65, s98, 163840
    buffer_load_dwordx4 v224, s[20:23], s65 offen offset:0 lds
    buffer_load_dwordx4 v225, s[20:23], s65 offen offset:1024 lds
    buffer_load_dwordx4 v226, s[20:23], s65 offen offset:2048 lds
    buffer_load_dwordx4 v227, s[20:23], s65 offen offset:3072 lds
    s_add_u32 m0, m0, 4096
    s_nop 0
    buffer_load_dwordx4 v228, s[20:23], s65 offen lds
    s_waitcnt lgkmcnt(0)
    s_barrier
    s_setprio 0
    ds_read_b128 v[216:219], v206 offset:512
    ds_read_b128 v[220:223], v206 offset:768
    s_lshl_b32 s58, s5, 7
    v_lshlrev_b32 v45, 10, v0
    v_mov_b32 v44, 0xff81ff91
    s_cmp_eq_u32 s4, 7
    s_cbranch_scc0 L_ah
    s_mov_b64 exec, 15
    v_mov_b32 v44, 0
    buffer_atomic_or v44, v45, s[16:19], s58 offen sc0 sc1
    s_mov_b64 exec, -1
L_ah:
    s_add_u32 m0, s97, 40960
    s_add_u32 s65, s96, 327680
    buffer_load_dwordx4 v224, s[20:23], s65 offen offset:0 lds
    buffer_load_dwordx4 v225, s[20:23], s65 offen offset:1024 lds
    buffer_load_dwordx4 v226, s[20:23], s65 offen offset:2048 lds
    buffer_load_dwordx4 v227, s[20:23], s65 offen offset:3072 lds
    s_add_u32 m0, m0, 4096
    s_nop 0
    buffer_load_dwordx4 v228, s[20:23], s65 offen lds
    s_barrier
    ds_read_b128 v[136:139], v240 offset:4096
    ds_read_b64 v[140:141], v242 offset:4096
    ds_read_b128 v[142:145], v240 offset:6144
    ds_read_b64 v[146:147], v242 offset:6144
    s_waitcnt lgkmcnt(2)
    v_mfma_f32_16x16x32_bf16 v[96:99], v[176:179], v[136:139], 0
    v_mfma_f32_16x16x32_bf16 v[100:103], v[180:183], v[136:139], 0
    v_mfma_f32_16x16x32_bf16 v[104:107], v[184:187], v[136:139], 0
    v_mfma_f32_16x16x32_bf16 v[108:111], v[188:191], v[136:139], 0
    v_mfma_f32_16x16x32_bf16 v[112:115], v[192:195], v[136:139], 0
    v_mfma_f32_16x16x16_bf16 v[96:99], v[196:197], v[140:141], v[96:99]
    v_mfma_f32_16x16x16_bf16 v[100:103], v[198:199], v[140:141], v[100:103]
    v_mfma_f32_16x16x16_bf16 v[104:107], v[200:201], v[140:141], v[104:107]
    v_mfma_f32_16x16x16_bf16 v[108:111], v[202:203], v[140:141], v[108:111]
    v_mfma_f32_16x16x16_bf16 v[112:115], v[204:205], v[140:141], v[112:115]
    s_waitcnt lgkmcnt(0)
    v_mfma_f32_16x16x32_bf16 v[116:119], v[176:179], v[142:145], 0
    v_mfma_f32_16x16x32_bf16 v[120:123], v[180:183], v[142:145], 0
    v_mfma_f32_16x16x32_bf16 v[124:127], v[184:187], v[142:145], 0
    v_max3_f32 v236, v96, v97, v98
    s_add_u32 m0, s99, 61440
    s_add_u32 s65, s98, 491520
    buffer_load_dwordx4 v224, s[20:23], s65 offen offset:0 lds
    v_max3_f32 v237, v99, v100, v101
    v_max3_f32 v236, v236, v102, v103
    buffer_load_dwordx4 v225, s[20:23], s65 offen offset:1024 lds
    v_max3_f32 v237, v237, v104, v105
    v_max3_f32 v236, v236, v106, v107
    v_max3_f32 v237, v237, v108, v109
    buffer_load_dwordx4 v226, s[20:23], s65 offen offset:2048 lds
    v_max3_f32 v236, v236, v110, v111
    v_max3_f32 v237, v237, v112, v113
    buffer_load_dwordx4 v227, s[20:23], s65 offen offset:3072 lds
    v_max3_f32 v236, v236, v114, v115
    v_max_f32 v236, v236, v237
    v_mul_f32 v236, v219, v236
    v_fma_f32 v96, v96, v219, -v236
    v_fma_f32 v97, v97, v219, -v236
    s_add_u32 m0, m0, 4096
    s_nop 0
    buffer_load_dwordx4 v228, s[20:23], s65 offen lds
    v_fma_f32 v98, v98, v219, -v236
    v_fma_f32 v99, v99, v219, -v236
    v_mfma_f32_16x16x32_bf16 v[128:131], v[188:191], v[142:145], 0
    v_fma_f32 v100, v100, v219, -v236
    v_fma_f32 v101, v101, v219, -v236
    v_fma_f32 v102, v102, v219, -v236
    v_mfma_f32_16x16x32_bf16 v[132:135], v[192:195], v[142:145], 0
    v_fma_f32 v103, v103, v219, -v236
    v_fma_f32 v104, v104, v219, -v236
    v_fma_f32 v105, v105, v219, -v236
    v_mfma_f32_16x16x16_bf16 v[116:119], v[196:197], v[146:147], v[116:119]
    v_fma_f32 v106, v106, v219, -v236
    v_fma_f32 v107, v107, v219, -v236
    v_mfma_f32_16x16x16_bf16 v[120:123], v[198:199], v[146:147], v[120:123]
    v_fma_f32 v108, v108, v219, -v236
    v_fma_f32 v109, v109, v219, -v236
    v_fma_f32 v110, v110, v219, -v236
    v_mfma_f32_16x16x16_bf16 v[124:127], v[200:201], v[146:147], v[124:127]
    v_fma_f32 v111, v111, v219, -v236
    v_fma_f32 v112, v112, v219, -v236
    v_mfma_f32_16x16x16_bf16 v[128:131], v[202:203], v[146:147], v[128:131]
    v_fma_f32 v113, v113, v219, -v236
    v_fma_f32 v114, v114, v219, -v236
    v_fma_f32 v115, v115, v219, -v236
    v_mfma_f32_16x16x16_bf16 v[132:135], v[204:205], v[146:147], v[132:135]
    v_exp_f32 v96, v96
    v_exp_f32 v97, v97
    v_exp_f32 v98, v98
    v_exp_f32 v99, v99
    v_exp_f32 v100, v100
    v_exp_f32 v101, v101
    v_exp_f32 v102, v102
    v_exp_f32 v103, v103
    v_exp_f32 v104, v104
    v_exp_f32 v105, v105
    v_exp_f32 v106, v106
    v_exp_f32 v107, v107
    v_exp_f32 v108, v108
    v_exp_f32 v109, v109
    v_exp_f32 v110, v110
    v_exp_f32 v111, v111
    v_exp_f32 v112, v112
    v_exp_f32 v113, v113
    s_mov_b64 exec, 1
    buffer_load_dword v253, off, s[16:19], s39 sc1
    s_mov_b64 exec, -1
    v_exp_f32 v114, v114
    v_exp_f32 v115, v115
    v_add_f32 v236, v96, v97
    v_add_f32 v237, v98, v99
    v_add_f32 v236, v236, v100
    v_add_f32 v237, v237, v101
    v_add_f32 v236, v236, v102
    v_add_f32 v237, v237, v103
    v_add_f32 v236, v236, v104
    v_add_f32 v237, v237, v105
    v_add_f32 v236, v236, v106
    v_add_f32 v237, v237, v107
    v_add_f32 v236, v236, v108
    v_add_f32 v237, v237, v109
    v_add_f32 v236, v236, v110
    v_add_f32 v237, v237, v111
    v_add_f32 v236, v236, v112
    v_add_f32 v237, v237, v113
    v_add_f32 v236, v236, v114
    v_add_f32 v237, v237, v115
    v_add_f32 v236, v236, v237
    v_rcp_f32 v236, v236
    s_nop 0
    v_mul_f32 v236, v236, v218
    v_mul_f32 v96, v96, v236
    v_mul_f32 v97, v97, v236
    v_mul_f32 v98, v98, v236
    v_mul_f32 v99, v99, v236
    v_mul_f32 v100, v100, v236
    v_mul_f32 v101, v101, v236
    v_mul_f32 v102, v102, v236
    v_mul_f32 v103, v103, v236
    v_mul_f32 v104, v104, v236
    v_mul_f32 v105, v105, v236
    v_mul_f32 v106, v106, v236
    v_mul_f32 v107, v107, v236
    v_mul_f32 v108, v108, v236
    v_mul_f32 v109, v109, v236
    v_mul_f32 v110, v110, v236
    v_mul_f32 v111, v111, v236
    v_mul_f32 v112, v112, v236
    v_mul_f32 v113, v113, v236
    v_mul_f32 v114, v114, v236
    v_mul_f32 v115, v115, v236
    v_cvt_pk_bf16_f32 v156, v96, v97
    v_cvt_pk_bf16_f32 v157, v98, v99
    v_cvt_pk_bf16_f32 v158, v100, v101
    v_cvt_pk_bf16_f32 v159, v102, v103
    ds_write_b128 v240, v[156:159] offset:4096
    v_cvt_pk_bf16_f32 v160, v104, v105
    v_cvt_pk_bf16_f32 v161, v106, v107
    v_cvt_pk_bf16_f32 v162, v108, v109
    v_cvt_pk_bf16_f32 v163, v110, v111
    ds_write_b128 v241, v[160:163] offset:4096
    v_cvt_pk_bf16_f32 v164, v112, v113
    v_cvt_pk_bf16_f32 v165, v114, v115
    ds_write_b64 v242, v[164:165] offset:4096
    v_mov_b32 v234, v223
    v_max3_f32 v236, v116, v117, v118
    v_max3_f32 v237, v119, v120, v121
    v_max3_f32 v236, v236, v122, v123
    v_max3_f32 v237, v237, v124, v125
    v_max3_f32 v236, v236, v126, v127
    v_max3_f32 v237, v237, v128, v129
    v_max3_f32 v236, v236, v130, v131
    v_max3_f32 v237, v237, v132, v133
    v_max3_f32 v236, v236, v134, v135
    v_max_f32 v236, v236, v237
    v_mul_f32 v235, v234, v236
    v_pk_fma_f32 v[116:117], v[116:117], v[234:235], v[234:235] op_sel:[0,0,1] op_sel_hi:[1,0,1] neg_lo:[0,0,1] neg_hi:[0,0,1]
    v_pk_fma_f32 v[118:119], v[118:119], v[234:235], v[234:235] op_sel:[0,0,1] op_sel_hi:[1,0,1] neg_lo:[0,0,1] neg_hi:[0,0,1]
    v_pk_fma_f32 v[120:121], v[120:121], v[234:235], v[234:235] op_sel:[0,0,1] op_sel_hi:[1,0,1] neg_lo:[0,0,1] neg_hi:[0,0,1]
    v_pk_fma_f32 v[122:123], v[122:123], v[234:235], v[234:235] op_sel:[0,0,1] op_sel_hi:[1,0,1] neg_lo:[0,0,1] neg_hi:[0,0,1]
    v_pk_fma_f32 v[124:125], v[124:125], v[234:235], v[234:235] op_sel:[0,0,1] op_sel_hi:[1,0,1] neg_lo:[0,0,1] neg_hi:[0,0,1]
    v_pk_fma_f32 v[126:127], v[126:127], v[234:235], v[234:235] op_sel:[0,0,1] op_sel_hi:[1,0,1] neg_lo:[0,0,1] neg_hi:[0,0,1]
    v_pk_fma_f32 v[128:129], v[128:129], v[234:235], v[234:235] op_sel:[0,0,1] op_sel_hi:[1,0,1] neg_lo:[0,0,1] neg_hi:[0,0,1]
    v_pk_fma_f32 v[130:131], v[130:131], v[234:235], v[234:235] op_sel:[0,0,1] op_sel_hi:[1,0,1] neg_lo:[0,0,1] neg_hi:[0,0,1]
    v_pk_fma_f32 v[132:133], v[132:133], v[234:235], v[234:235] op_sel:[0,0,1] op_sel_hi:[1,0,1] neg_lo:[0,0,1] neg_hi:[0,0,1]
    v_pk_fma_f32 v[134:135], v[134:135], v[234:235], v[234:235] op_sel:[0,0,1] op_sel_hi:[1,0,1] neg_lo:[0,0,1] neg_hi:[0,0,1]
    v_exp_f32 v116, v116
    v_exp_f32 v117, v117
    v_exp_f32 v118, v118
    v_exp_f32 v119, v119
    v_exp_f32 v120, v120
    v_exp_f32 v121, v121
    s_waitcnt vmcnt(0)
    buffer_load_dwordx4 v[16:19], v7, s[16:19], s38 offen sc1
    v_exp_f32 v122, v122
    v_exp_f32 v123, v123
    v_exp_f32 v124, v124
    v_exp_f32 v125, v125
    v_exp_f32 v126, v126
    buffer_load_dwordx2 v[20:21], v1, s[16:19], s38 offen offset:1024 sc1
    v_exp_f32 v127, v127
    v_exp_f32 v128, v128
    v_exp_f32 v129, v129
    v_exp_f32 v130, v130
    v_exp_f32 v131, v131
    buffer_load_dword v94, v255, s[16:19], 0 offen sc1
    v_exp_f32 v132, v132
    v_exp_f32 v133, v133
    v_exp_f32 v134, v134
    v_exp_f32 v135, v135
    v_pk_add_f32 v[236:237], v[116:117], v[118:119]
    v_pk_add_f32 v[238:239], v[120:121], v[122:123]
    v_pk_add_f32 v[236:237], v[236:237], v[124:125]
    v_pk_add_f32 v[238:239], v[238:239], v[126:127]
    v_pk_add_f32 v[236:237], v[236:237], v[128:129]
    v_pk_add_f32 v[238:239], v[238:239], v[130:131]
    v_pk_add_f32 v[236:237], v[236:237], v[132:133]
    v_pk_add_f32 v[238:239], v[238:239], v[134:135]
    v_pk_add_f32 v[236:237], v[236:237], v[238:239]
    v_add_f32 v236, v236, v237
    v_rcp_f32 v236, v236
    s_nop 0
    v_mul_f32 v236, v236, v222
    v_pk_mul_f32 v[116:117], v[116:117], v[236:237] op_sel_hi:[1,0]
    v_pk_mul_f32 v[118:119], v[118:119], v[236:237] op_sel_hi:[1,0]
    v_pk_mul_f32 v[120:121], v[120:121], v[236:237] op_sel_hi:[1,0]
    v_pk_mul_f32 v[122:123], v[122:123], v[236:237] op_sel_hi:[1,0]
    v_pk_mul_f32 v[124:125], v[124:125], v[236:237] op_sel_hi:[1,0]
    v_pk_mul_f32 v[126:127], v[126:127], v[236:237] op_sel_hi:[1,0]
    v_pk_mul_f32 v[128:129], v[128:129], v[236:237] op_sel_hi:[1,0]
    v_pk_mul_f32 v[130:131], v[130:131], v[236:237] op_sel_hi:[1,0]
    v_pk_mul_f32 v[132:133], v[132:133], v[236:237] op_sel_hi:[1,0]
    v_pk_mul_f32 v[134:135], v[134:135], v[236:237] op_sel_hi:[1,0]
    v_cvt_pk_bf16_f32 v156, v116, v117
    v_cvt_pk_bf16_f32 v157, v118, v119
    v_cvt_pk_bf16_f32 v158, v120, v121
    v_cvt_pk_bf16_f32 v159, v122, v123
    ds_write_b128 v240, v[156:159] offset:6144
    v_cvt_pk_bf16_f32 v160, v124, v125
    v_cvt_pk_bf16_f32 v161, v126, v127
    v_cvt_pk_bf16_f32 v162, v128, v129
    v_cvt_pk_bf16_f32 v163, v130, v131
    ds_write_b128 v241, v[160:163] offset:6144
    v_cvt_pk_bf16_f32 v164, v132, v133
    v_cvt_pk_bf16_f32 v165, v134, v135
    ds_write_b64 v242, v[164:165] offset:6144
    v_cmp_ne_u32 vcc, 0xff81ff91, v44
    s_cbranch_vccz L_ah2
    s_mov_b64 exec, 0xf
    s_mov_b32 s3, 0
L_cp_14:
    v_mov_b32 v44, 0
    s_add_u32 s3, s3, 1
    s_cmp_gt_u32 s3, 200000
    s_cbranch_scc1 L_cdone_15
    buffer_atomic_or v44, v45, s[16:19], s58 offen sc0 sc1
    s_waitcnt vmcnt(0)
    v_cmp_ne_u32 vcc, 0xff81ff91, v44
    s_cbranch_vccnz L_cp_14
L_cdone_15:
    s_mov_b64 exec, -1
L_ah2:
    s_setprio 2
    s_waitcnt lgkmcnt(0)
    s_barrier
    s_waitcnt vmcnt(0)
    s_branch L_qchk
L_lq:
    v_cmp_ne_u32 vcc, s64, v44
    v_mov_b32 v46, 156928
    s_or_b32 s64, vcc_lo, vcc_hi
    v_mov_b32 v44, s64
    s_cmp_eq_u32 s60, 0
    s_cbranch_scc0 L_lq1
    ds_write_b32 v46, v44
L_lq1:
    s_waitcnt lgkmcnt(0)
    s_barrier
    s_setprio 0
    v_lshlrev_b32 v252, 10, v0
    s_barrier
    s_branch L_ophase
L_mfma:
    s_setprio 0
    s_mov_b32 s18, 268435456
    s_mov_b32 s19, 0x20000
    s_mov_b32 s34, 25600
    s_mov_b32 s35, 0x20000
    s_mov_b32 s22, 819200
    s_mov_b32 s23, 0x20000
    s_mov_b32 s26, 2621440
    s_mov_b32 s27, 0x20000
    s_mov_b32 s30, 256
    s_mov_b32 s31, 0x20000
    s_mov_b32 s52, 0xff81ff81
    s_and_b32 s60, s4, 1
    s_lshr_b32 s61, s4, 1
    v_lshrrev_b32 v3, 4, v0
    v_bfe_u32 v4, v0, 2, 2
    v_and_b32 v5, 3, v0
    v_and_b32 v6, 15, v0
    v_mul_u32_u24 v7, 5152, v3
    v_mul_u32_u24 v12, 320, v4
    s_movk_i32 s3, 16384
    v_add3_u32 v7, v7, v12, s3
    s_mul_i32 s66, s60, 80
    s_sub_u32 s67, 240, s66
    v_lshl_add_u32 v12, v5, 3, v7
    v_add_u32 v9, s66, v12
    v_add_u32 v10, s67, v12
    v_mov_b32 v12, s66
    v_mov_b32 v13, s67
    v_cmp_lt_u32 vcc, 1, v5
    v_and_b32 v14, 1, v5
    v_mul_u32_u24 v14, 72, v14
    v_cndmask_b32 v15, v12, v13, vcc
    v_add3_u32 v11, v7, v15, v14
    v_and_b32 v7, 2, v0
    v_bfe_u32 v14, v0, 2, 1
    v_or_b32 v7, v7, v14
    v_bfe_u32 v14, v0, 3, 1
    v_lshl_add_u32 v7, v14, 2, v7
    v_lshlrev_b32 v14, 1, v3
    v_xor_b32 v7, v7, v14
    v_lshlrev_b32 v7, 4, v7
    v_lshl_add_u32 v7, v6, 7, v7
    s_lshl_b32 s3, s61, 13
    v_add_u32 v8, s3, v7
    v_add_u32 v168, 40960, v8
    v_add_u32 v170, 40960, v9
    v_add_u32 v171, 40960, v10
    v_add_u32 v172, 40960, v11
    v_xor_b32 v169, 16, v168
    v_min_u32 v7, 2, v3
    v_mul_u32_u24 v7, 640, v7
    v_add_u32 v7, 155008, v7
    v_lshl_add_u32 v14, v6, 2, v7
    v_lshl_add_u32 v173, v12, 1, v14
    v_lshl_add_u32 v174, v13, 1, v14
    v_cmp_lt_u32 vcc, 1, v4
    v_and_b32 v14, 1, v4
    v_mul_u32_u24 v14, 144, v14
    v_cndmask_b32 v15, v12, v13, vcc
    v_lshl_add_u32 v15, v15, 1, v14
    v_lshl_add_u32 v14, v5, 2, v7
    v_add_u32 v175, v14, v15
    s_lshl_b32 s3, s61, 10
    s_add_u32 s3, s3, 152960
    v_lshl_add_u32 v206, v6, 4, s3
    v_mov_b64 v[16:17], 0
    v_mov_b64 v[18:19], 0
    v_mov_b64 v[20:21], 0
    v_mov_b64 v[22:23], 0
    v_mov_b64 v[24:25], 0
    v_mov_b64 v[26:27], 0
    v_mov_b64 v[28:29], 0
    v_mov_b64 v[30:31], 0
    v_mov_b64 v[32:33], 0
    v_mov_b64 v[34:35], 0
    v_mov_b64 v[36:37], 0
    v_mov_b64 v[38:39], 0
    v_mov_b64 v[40:41], 0
    v_mov_b64 v[42:43], 0
    v_mov_b64 v[44:45], 0
    v_mov_b64 v[46:47], 0
    v_mov_b64 v[48:49], 0
    v_mov_b64 v[50:51], 0
    v_mov_b64 v[52:53], 0
    v_mov_b64 v[54:55], 0
    v_mov_b64 v[56:57], 0
    v_mov_b64 v[58:59], 0
    v_mov_b64 v[60:61], 0
    v_mov_b64 v[62:63], 0
    v_mov_b64 v[64:65], 0
    v_mov_b64 v[66:67], 0
    v_mov_b64 v[68:69], 0
    v_mov_b64 v[70:71], 0
    v_mov_b64 v[72:73], 0
    v_mov_b64 v[74:75], 0
    v_mov_b64 v[76:77], 0
    v_mov_b64 v[78:79], 0
    v_mov_b64 v[80:81], 0
    v_mov_b64 v[82:83], 0
    v_mov_b64 v[84:85], 0
    v_mov_b64 v[86:87], 0
    v_mov_b64 v[88:89], 0
    v_mov_b64 v[90:91], 0
    v_mov_b64 v[92:93], 0
    v_mov_b64 v[94:95], 0
    v_mov_b64 v[132:133], 0
    v_mov_b64 v[134:135], 0
    v_mov_b64 v[136:137], 0
    v_mov_b64 v[138:139], 0
    v_mov_b64 v[140:141], 0
    v_mov_b64 v[142:143], 0
    v_mov_b64 v[144:145], 0
    v_mov_b64 v[146:147], 0
    v_mov_b64 v[148:149], 0
    v_mov_b64 v[150:151], 0
    v_mov_b64 v[152:153], 0
    v_mov_b64 v[154:155], 0
    v_mov_b64 v[156:157], 0
    v_mov_b64 v[158:159], 0
    v_mov_b64 v[160:161], 0
    v_mov_b64 v[162:163], 0
    v_mov_b64 v[164:165], 0
    v_mov_b64 v[166:167], 0
    v_mov_b32 v225, 0
    v_mov_b32 v227, 0
    v_mov_b32 v229, 0
    v_mov_b32 v231, 0
    v_mov_b32 v233, 0
    s_mov_b32 s68, 0
    s_mov_b32 s69, 40960
    s_lshr_b32 s36, s7, 2
    s_lshr_b32 s3, s7, 1
    s_sub_u32 s3, s3, 4
    s_cmp_lt_u32 s57, 8
    s_cselect_b32 s36, s36, s3
    s_and_b32 s3, s5, 3
    s_lshl3_add_u32 s36, s3, s36
    s_lshl_b32 s3, s7, 1
    s_cmp_lt_u32 s57, 8
    s_cselect_b32 s3, s7, s3
    s_and_b32 s3, s3, 3
    s_and_b32 s37, s5, 4
    s_add_u32 s37, s37, s3
    s_lshl3_add_u32 s37, s37, s4
    s_lshl_b32 s3, s36, 6
    s_add_u32 s3, s3, s37
    s_mul_i32 s38, s3, 1280
    s_add_u32 s38, s38, 65536
    s_and_b32 s39, s37, 60
    s_lshr_b32 s3, s36, 3
    s_add_u32 s39, s39, s3
    s_lshl_b32 s39, s39, 7
    s_add_u32 s39, s39, 45056
    s_and_b32 s3, s37, 2
    s_lshl3_add_u32 s39, s3, s39
    s_and_b32 s3, s36, 6
    s_lshl1_add_u32 s39, s3, s39
    s_mul_i32 s40, s36, 28672
    s_add_u32 s40, s40, 2924544
    s_mul_i32 s41, s37, 40960
    s_add_u32 s41, s41, 4259840
    s_lshl_b32 s3, s36, 7
    s_add_u32 s42, s41, s3
    s_add_u32 s42, s42, 16384
    s_lshl2_add_u32 s41, s3, s41
    s_lshr_b32 s3, s5, 2
    s_and_b32 s44, s7, 1
    s_lshl1_add_u32 s44, s3, s44
    s_and_b32 s3, s36, 28
    s_add_u32 s3, s3, s44
    s_lshl_b32 s3, s3, 7
    s_add_u32 s44, s3, 53248
    s_cmp_lt_u32 s57, 8
    s_cbranch_scc0 L_qaddr
    v_and_b32 v7, 1, v0
    v_bfe_u32 v12, v0, 1, 1
    v_lshl_or_b32 v7, v12, 2, v7
    v_bfe_u32 v12, v0, 2, 1
    v_lshl_or_b32 v7, v12, 1, v7
    v_lshlrev_b32 v7, 4, v7
    s_lshl_b32 s3, s61, 13
    s_add_u32 s3, s3, 86016
    v_lshl_add_u32 v7, v6, 7, v7
    v_add_u32 v7, s3, v7
    s_lshl_b32 s58, s60, 15
    v_lshrrev_b32 v12, 1, v3
    v_and_b32 v13, 1, v3
    v_lshl_add_u32 v14, v12, 14, v7
    v_add_u32 v14, s58, v14
    v_lshlrev_b32 v15, 5, v13
    v_xor_b32 v240, v14, v15
    v_xor_b32 v241, 16, v240
    v_xor_b32 v242, 96, v14
    v_lshl_add_u32 v242, v13, 3, v242
    s_sub_u32 s59, 32768, s58
    v_add_u32 v14, s59, v7
    v_lshlrev_b32 v15, 4, v12
    v_xor_b32 v243, 64, v14
    v_xor_b32 v243, v243, v15
    v_lshl_add_u32 v243, v13, 3, v243
    v_xor_b32 v14, 112, v14
    v_lshl_add_u32 v14, v13, 14, v14
    v_xor_b32 v12, 1, v12
    v_lshl_add_u32 v244, v12, 3, v14
    v_lshrrev_b32 v7, 5, v0
    v_lshl_add_u32 v12, v7, 3, v4
    v_lshlrev_b32 v12, 7, v12
    v_and_b32 v13, 1, v4
    v_lshrrev_b32 v14, 1, v4
    v_lshl_or_b32 v13, v14, 2, v13
    v_lshl_or_b32 v12, v13, 4, v12
    s_lshl_b32 s3, s4, 14
    s_add_u32 s3, s3, 86016
    v_add_u32 v12, s3, v12
    v_and_b32 v13, 1, v5
    v_lshrrev_b32 v14, 1, v5
    v_and_b32 v15, 1, v3
    v_lshl_or_b32 v247, v13, 1, v15
    v_lshlrev_b32 v247, 4, v247
    v_xor_b32 v247, v247, v12
    v_lshl_add_u32 v247, v14, 3, v247
    v_xor_b32 v249, 96, v12
    v_lshl_add_u32 v249, v13, 3, v249
    s_cmp_eq_u32 s60, 0
    s_mov_b32 s3, 0xfffeba98
    s_cselect_b32 s3, 0xfffba98e, s3
    v_lshl_add_u32 v13, v15, 2, v5
    v_lshlrev_b32 v13, 2, v13
    v_bfe_u32 v13, s3, v13, 4
    v_lshlrev_b32 v13, 3, v13
    v_xor_b32 v245, v13, v12
    v_xor_b32 v246, 32, v245
    v_xor_b32 v248, 32, v247
    v_xor_b32 v250, 32, v249
    v_and_b32 v13, 31, v0
    v_mul_u32_u24 v14, 21, v7
    v_add_u32 v14, v14, v13
    v_cmp_lt_u32 vcc, 20, v13
    v_mov_b32 v15, 0x7ff00000
    v_lshlrev_b32 v251, 4, v14
    v_lshlrev_b32 v252, 3, v14
    v_cndmask_b32 v251, v251, v15, vcc
    v_cndmask_b32 v252, v252, v15, vcc
    s_lshl2_add_u32 s3, s57, s4
    s_lshl4_add_u32 s3, s3, s54
    s_mul_i32 s62, s3, 1792
    s_add_u32 s62, s62, 2924544
    s_lshl_b32 s3, s57, 9
    s_add_u32 s3, s3, 53248
    s_cmp_eq_u32 s4, 3
    s_cselect_b32 s43, s3, 0x7ff00000
    v_lshrrev_b32 v7, 1, v5
    v_mul_u32_u24 v12, 640, v7
    v_lshl_add_u32 v13, v3, 2, v4
    v_mul_u32_u24 v13, 40, v13
    v_add3_u32 v12, v12, v13, s65
    v_mul_u32_u24 v13, 1440, v7
    v_mul_u32_u24 v14, 40, v4
    v_add3_u32 v13, v13, v14, s65
    v_bfe_u32 v7, v0, 3, 1
    v_add_u32 v14, -1, v7
    v_not_b32 v15, v14
    v_cmp_eq_u32 vcc, v7, v3
    v_bfe_i32 v2, v0, 2, 1
    v_and_b32 v2, 0x80008000, v2
    v_cndmask_b32 v7, 0, -1, vcc
    s_waitcnt vmcnt(0)
    ds_read_b64_tr_b16 v[176:177], v12 offset:160
    ds_read_b64_tr_b16 v[196:197], v13 offset:0
    ds_read_b64_tr_b16 v[180:181], v12 offset:168
    ds_read_b64_tr_b16 v[198:199], v13 offset:8
    ds_read_b64_tr_b16 v[184:185], v12 offset:176
    ds_read_b64_tr_b16 v[200:201], v13 offset:16
    ds_read_b64_tr_b16 v[188:189], v12 offset:184
    ds_read_b64_tr_b16 v[202:203], v13 offset:24
    ds_read_b64_tr_b16 v[192:193], v12 offset:192
    ds_read_b64_tr_b16 v[204:205], v13 offset:32
    s_waitcnt lgkmcnt(0)
    v_bitop3_b32 v178, v176, v2, v15 bitop3:0x28
    v_bitop3_b32 v176, v176, v2, v14 bitop3:0x28
    v_bitop3_b32 v196, v196, v2, v7 bitop3:0x28
    v_bitop3_b32 v179, v177, v2, v15 bitop3:0x28
    v_bitop3_b32 v177, v177, v2, v14 bitop3:0x28
    v_bitop3_b32 v197, v197, v2, v7 bitop3:0x28
    v_bitop3_b32 v182, v180, v2, v15 bitop3:0x28
    v_bitop3_b32 v180, v180, v2, v14 bitop3:0x28
    v_bitop3_b32 v198, v198, v2, v7 bitop3:0x28
    v_bitop3_b32 v183, v181, v2, v15 bitop3:0x28
    v_bitop3_b32 v181, v181, v2, v14 bitop3:0x28
    v_bitop3_b32 v199, v199, v2, v7 bitop3:0x28
    v_bitop3_b32 v186, v184, v2, v15 bitop3:0x28
    v_bitop3_b32 v184, v184, v2, v14 bitop3:0x28
    v_bitop3_b32 v200, v200, v2, v7 bitop3:0x28
    v_bitop3_b32 v187, v185, v2, v15 bitop3:0x28
    v_bitop3_b32 v185, v185, v2, v14 bitop3:0x28
    v_bitop3_b32 v201, v201, v2, v7 bitop3:0x28
    v_bitop3_b32 v190, v188, v2, v15 bitop3:0x28
    v_bitop3_b32 v188, v188, v2, v14 bitop3:0x28
    v_bitop3_b32 v202, v202, v2, v7 bitop3:0x28
    v_bitop3_b32 v191, v189, v2, v15 bitop3:0x28
    v_bitop3_b32 v189, v189, v2, v14 bitop3:0x28
    v_bitop3_b32 v203, v203, v2, v7 bitop3:0x28
    v_bitop3_b32 v194, v192, v2, v15 bitop3:0x28
    v_bitop3_b32 v192, v192, v2, v14 bitop3:0x28
    v_bitop3_b32 v204, v204, v2, v7 bitop3:0x28
    v_bitop3_b32 v195, v193, v2, v15 bitop3:0x28
    v_bitop3_b32 v193, v193, v2, v14 bitop3:0x28
    v_bitop3_b32 v205, v205, v2, v7 bitop3:0x28
L_qaret:
    v_lshlrev_b32 v7, 4, v0
    v_and_b32 v96, 31, v0
    v_lshlrev_b32 v1, 3, v96
    s_lshl_b32 s3, s37, 7
    s_add_u32 s3, s3, 8192
    v_lshl_add_u32 v255, v96, 2, s3
    v_mov_b32 v98, 0x7ff00000
    v_mov_b32 v253, 0
    s_lshl_b32 s3, s4, 4
    v_and_b32 v14, 15, v0
    v_add_u32 v14, s3, v14
    v_cmp_lt_u32 vcc, 104, v14
    v_lshlrev_b32 v14, 4, v14
    v_lshrrev_b32 v99, 4, v0
    v_mul_u32_u24 v15, 7168, v99
    v_add_u32 v15, v15, v14
    v_cndmask_b32 v15, v15, v98, vcc
    v_and_b32 v99, 1, v99
    v_lshl_add_u32 v14, v99, 3, v14
    v_add_u32 v14, 156928, v14
L_mloop:
    s_barrier
    v_mfma_f32_16x16x32_bf16 v[28:31], v[160:163], v[132:135], v[28:31]
    ds_read_b128 v[96:99], v168 offset:0
    ds_read_b64_tr_b16 v[112:113], v170 offset:8
    v_mfma_f32_16x16x32_bf16 v[48:51], v[160:163], v[136:139], v[48:51]
    ds_read_b64_tr_b16 v[114:115], v170 offset:1288
    ds_read_b128 v[100:103], v168 offset:2048
    v_mfma_f32_16x16x32_bf16 v[68:71], v[160:163], v[140:143], v[68:71]
    ds_read_b128 v[104:107], v168 offset:4096
    ds_read_b128 v[108:111], v168 offset:6144
    v_mfma_f32_16x16x32_bf16 v[88:91], v[160:163], v[144:147], v[88:91]
    ds_read_b64_tr_b16 v[116:117], v170 offset:40
    ds_read_b64_tr_b16 v[118:119], v170 offset:1320
    v_mfma_f32_16x16x32_bf16 v[32:35], v[164:167], v[132:135], v[32:35]
    ds_read_b64_tr_b16 v[120:121], v171 offset:8
    ds_read_b64_tr_b16 v[122:123], v171 offset:1288
    v_mfma_f32_16x16x32_bf16 v[52:55], v[164:167], v[136:139], v[52:55]
    ds_read_b64_tr_b16 v[124:125], v171 offset:40
    ds_read_b64_tr_b16 v[126:127], v171 offset:1320
    v_mfma_f32_16x16x32_bf16 v[72:75], v[164:167], v[140:143], v[72:75]
    ds_read_b64_tr_b16 v[128:129], v172 offset:0
    ds_read_b64_tr_b16 v[130:131], v172 offset:1280
    v_mfma_f32_16x16x32_bf16 v[92:95], v[164:167], v[144:147], v[92:95]
    s_waitcnt lgkmcnt(11)
    v_mfma_f32_16x16x32_bf16 v[16:19], v[112:115], v[96:99], v[16:19]
    ds_read_b128 v[132:135], v169 offset:0
    s_waitcnt lgkmcnt(11)
    v_mfma_f32_16x16x32_bf16 v[36:39], v[112:115], v[100:103], v[36:39]
    ds_read_b64_tr_b16 v[148:149], v170 offset:2568
    s_waitcnt lgkmcnt(11)
    v_mfma_f32_16x16x32_bf16 v[56:59], v[112:115], v[104:107], v[56:59]
    ds_read_b64_tr_b16 v[150:151], v170 offset:3848
    s_waitcnt lgkmcnt(11)
    v_mfma_f32_16x16x32_bf16 v[76:79], v[112:115], v[108:111], v[76:79]
    ds_read_b128 v[136:139], v169 offset:2048
    s_waitcnt lgkmcnt(10)
    v_mfma_f32_16x16x32_bf16 v[20:23], v[116:119], v[96:99], v[20:23]
    ds_read_b128 v[140:143], v169 offset:4096
    v_mfma_f32_16x16x32_bf16 v[40:43], v[116:119], v[100:103], v[40:43]
    ds_read_b128 v[144:147], v169 offset:6144
    v_mfma_f32_16x16x32_bf16 v[60:63], v[116:119], v[104:107], v[60:63]
    ds_read_b64_tr_b16 v[152:153], v170 offset:2600
    v_mfma_f32_16x16x32_bf16 v[80:83], v[116:119], v[108:111], v[80:83]
    ds_read_b64_tr_b16 v[154:155], v170 offset:3880
    s_waitcnt lgkmcnt(12)
    v_mfma_f32_16x16x32_bf16 v[24:27], v[120:123], v[96:99], v[24:27]
    ds_read_b64_tr_b16 v[156:157], v171 offset:2568
    v_mfma_f32_16x16x32_bf16 v[44:47], v[120:123], v[100:103], v[44:47]
    ds_read_b64_tr_b16 v[158:159], v171 offset:3848
    v_mfma_f32_16x16x32_bf16 v[64:67], v[120:123], v[104:107], v[64:67]
    ds_read_b64_tr_b16 v[160:161], v171 offset:2600
    v_mfma_f32_16x16x32_bf16 v[84:87], v[120:123], v[108:111], v[84:87]
    ds_read_b64_tr_b16 v[162:163], v171 offset:3880
    s_waitcnt lgkmcnt(14)
    v_mfma_f32_16x16x32_bf16 v[28:31], v[124:127], v[96:99], v[28:31]
    ds_read_b64_tr_b16 v[164:165], v172 offset:2560
    v_mfma_f32_16x16x32_bf16 v[48:51], v[124:127], v[100:103], v[48:51]
    ds_read_b64_tr_b16 v[166:167], v172 offset:3840
    v_mfma_f32_16x16x32_bf16 v[68:71], v[124:127], v[104:107], v[68:71]
    s_add_u32 s69, s69, 36992
    s_cmp_eq_u32 s69, 151936
    s_cselect_b32 s69, 40960, s69
    v_mfma_f32_16x16x32_bf16 v[88:91], v[124:127], v[108:111], v[88:91]
    v_add_u32 v168, s69, v8
    s_waitcnt lgkmcnt(14)
    v_mfma_f32_16x16x32_bf16 v[32:35], v[128:131], v[96:99], v[32:35]
    v_add_u32 v170, s69, v9
    v_mfma_f32_16x16x32_bf16 v[52:55], v[128:131], v[100:103], v[52:55]
    v_add_u32 v171, s69, v10
    v_mfma_f32_16x16x32_bf16 v[72:75], v[128:131], v[104:107], v[72:75]
    v_add_u32 v172, s69, v11
    v_mfma_f32_16x16x32_bf16 v[92:95], v[128:131], v[108:111], v[92:95]
    v_xor_b32 v169, 16, v168
    s_waitcnt lgkmcnt(11)
    v_mfma_f32_16x16x32_bf16 v[16:19], v[148:151], v[132:135], v[16:19]
    s_add_u32 s68, s68, 1
    s_cmp_lt_u32 s68, 10
    s_waitcnt lgkmcnt(10)
    v_mfma_f32_16x16x32_bf16 v[36:39], v[148:151], v[136:139], v[36:39]
    s_waitcnt lgkmcnt(9)
    v_mfma_f32_16x16x32_bf16 v[56:59], v[148:151], v[140:143], v[56:59]
    s_waitcnt lgkmcnt(8)
    v_mfma_f32_16x16x32_bf16 v[76:79], v[148:151], v[144:147], v[76:79]
    s_waitcnt lgkmcnt(6)
    v_mfma_f32_16x16x32_bf16 v[20:23], v[152:155], v[132:135], v[20:23]
    v_mfma_f32_16x16x32_bf16 v[40:43], v[152:155], v[136:139], v[40:43]
    v_mfma_f32_16x16x32_bf16 v[60:63], v[152:155], v[140:143], v[60:63]
    v_mfma_f32_16x16x32_bf16 v[80:83], v[152:155], v[144:147], v[80:83]
    s_waitcnt lgkmcnt(4)
    v_mfma_f32_16x16x32_bf16 v[24:27], v[156:159], v[132:135], v[24:27]
    v_mfma_f32_16x16x32_bf16 v[44:47], v[156:159], v[136:139], v[44:47]
    v_mfma_f32_16x16x32_bf16 v[64:67], v[156:159], v[140:143], v[64:67]
    s_waitcnt lgkmcnt(0)
    v_mfma_f32_16x16x32_bf16 v[84:87], v[156:159], v[144:147], v[84:87]
    s_cbranch_scc1 L_mloop
    s_barrier
    v_mfma_f32_16x16x32_bf16 v[28:31], v[160:163], v[132:135], v[28:31]
    ds_read_b128 v[208:211], v206 offset:0
    ds_read_b128 v[212:215], v206 offset:256
    v_mfma_f32_16x16x32_bf16 v[48:51], v[160:163], v[136:139], v[48:51]
    ds_read_b128 v[216:219], v206 offset:512
    ds_read_b128 v[220:223], v206 offset:768
    v_mfma_f32_16x16x32_bf16 v[68:71], v[160:163], v[140:143], v[68:71]
    ds_read_b32 v224, v173 offset:16
    ds_read_b32 v226, v173 offset:80
    v_mfma_f32_16x16x32_bf16 v[88:91], v[160:163], v[144:147], v[88:91]
    ds_read_b32 v228, v174 offset:16
    ds_read_b32 v230, v174 offset:80
    v_mfma_f32_16x16x32_bf16 v[32:35], v[164:167], v[132:135], v[32:35]
    ds_read_b32 v232, v175 offset:0
    v_mfma_f32_16x16x32_bf16 v[52:55], v[164:167], v[136:139], v[52:55]
    v_mfma_f32_16x16x32_bf16 v[72:75], v[164:167], v[140:143], v[72:75]
    v_mfma_f32_16x16x32_bf16 v[92:95], v[164:167], v[144:147], v[92:95]
    s_waitcnt lgkmcnt(0)
    s_cmp_lt_u32 s57, 8
    s_cbranch_scc0 L_qepi
    v_cmp_gt_u32 vcc, 32, v0
    v_mfma_f32_16x16x16_bf16 v[56:59], v[224:225], v[216:217], v[56:59]
    v_mfma_f32_16x16x16_bf16 v[60:63], v[226:227], v[216:217], v[60:63]
    v_mfma_f32_16x16x16_bf16 v[64:67], v[228:229], v[216:217], v[64:67]
    v_mfma_f32_16x16x16_bf16 v[68:71], v[230:231], v[216:217], v[68:71]
    v_mfma_f32_16x16x16_bf16 v[72:75], v[232:233], v[216:217], v[72:75]
    v_mfma_f32_16x16x16_bf16 v[76:79], v[224:225], v[220:221], v[76:79]
    v_mfma_f32_16x16x16_bf16 v[80:83], v[226:227], v[220:221], v[80:83]
    s_nop 1
    v_cvt_pk_bf16_f32 v148, v56, v57
    v_cvt_pk_bf16_f32 v149, v58, v59
    v_mfma_f32_16x16x16_bf16 v[84:87], v[228:229], v[220:221], v[84:87]
    v_cvt_pk_bf16_f32 v150, v60, v61
    v_cvt_pk_bf16_f32 v151, v62, v63
    v_mfma_f32_16x16x16_bf16 v[88:91], v[230:231], v[220:221], v[88:91]
    v_cvt_pk_bf16_f32 v152, v72, v73
    v_cvt_pk_bf16_f32 v153, v74, v75
    v_mfma_f32_16x16x16_bf16 v[92:95], v[232:233], v[220:221], v[92:95]
    ds_write_b128 v240, v[148:151] offset:4096
    ds_write_b64 v242, v[152:153] offset:4096
    v_mfma_f32_16x16x16_bf16 v[16:19], v[224:225], v[208:209], v[16:19]
    v_cvt_pk_bf16_f32 v166, v76, v77
    v_cvt_pk_bf16_f32 v167, v78, v79
    v_mfma_f32_16x16x16_bf16 v[20:23], v[226:227], v[208:209], v[20:23]
    v_cvt_pk_bf16_f32 v168, v80, v81
    v_cvt_pk_bf16_f32 v169, v82, v83
    v_mfma_f32_16x16x16_bf16 v[24:27], v[228:229], v[208:209], v[24:27]
    v_cvt_pk_bf16_f32 v170, v92, v93
    v_cvt_pk_bf16_f32 v171, v94, v95
    v_mfma_f32_16x16x16_bf16 v[28:31], v[230:231], v[208:209], v[28:31]
    ds_write_b128 v240, v[166:169] offset:6144
    ds_write_b64 v242, v[170:171] offset:6144
    v_mfma_f32_16x16x16_bf16 v[32:35], v[232:233], v[208:209], v[32:35]
    v_mfma_f32_16x16x16_bf16 v[36:39], v[224:225], v[212:213], v[36:39]
    v_mfma_f32_16x16x16_bf16 v[40:43], v[226:227], v[212:213], v[40:43]
    v_cvt_pk_bf16_f32 v136, v16, v17
    v_cvt_pk_bf16_f32 v137, v18, v19
    v_mfma_f32_16x16x16_bf16 v[44:47], v[228:229], v[212:213], v[44:47]
    v_cvt_pk_bf16_f32 v138, v20, v21
    v_cvt_pk_bf16_f32 v139, v22, v23
    v_mfma_f32_16x16x16_bf16 v[48:51], v[230:231], v[212:213], v[48:51]
    v_cvt_pk_bf16_f32 v140, v32, v33
    v_cvt_pk_bf16_f32 v141, v34, v35
    v_mfma_f32_16x16x16_bf16 v[52:55], v[232:233], v[212:213], v[52:55]
    s_waitcnt lgkmcnt(0)
    s_barrier
    v_mfma_f32_16x16x32_bf16 v[96:99], v[176:179], v[136:139], 0
    v_cvt_pk_bf16_f32 v142, v36, v37
    v_cvt_pk_bf16_f32 v143, v38, v39
    v_mfma_f32_16x16x32_bf16 v[100:103], v[180:183], v[136:139], 0
    v_cvt_pk_bf16_f32 v144, v40, v41
    v_cvt_pk_bf16_f32 v145, v42, v43
    v_mfma_f32_16x16x32_bf16 v[104:107], v[184:187], v[136:139], 0
    v_cvt_pk_bf16_f32 v146, v52, v53
    v_cvt_pk_bf16_f32 v147, v54, v55
    v_mfma_f32_16x16x32_bf16 v[108:111], v[188:191], v[136:139], 0
    v_cvt_pk_bf16_f32 v8, v64, v65
    v_cvt_pk_bf16_f32 v9, v66, v67
    v_mfma_f32_16x16x32_bf16 v[112:115], v[192:195], v[136:139], 0
    v_cvt_pk_bf16_f32 v10, v68, v69
    v_cvt_pk_bf16_f32 v11, v70, v71
    v_mfma_f32_16x16x16_bf16 v[96:99], v[196:197], v[140:141], v[96:99]
    v_cndmask_b32 v152, v152, v217, vcc
    v_cndmask_b32 v153, v153, v225, vcc
    v_mfma_f32_16x16x16_bf16 v[100:103], v[198:199], v[140:141], v[100:103]
    ds_write_b64 v243, v[8:9] offset:4096
    ds_write_b64 v243, v[10:11] offset:20480
    v_mfma_f32_16x16x16_bf16 v[104:107], v[200:201], v[140:141], v[104:107]
    ds_write_b64 v244, v[152:153] offset:4096
    v_cvt_pk_bf16_f32 v172, v84, v85
    v_mfma_f32_16x16x16_bf16 v[108:111], v[202:203], v[140:141], v[108:111]
    v_cvt_pk_bf16_f32 v173, v86, v87
    v_cvt_pk_bf16_f32 v174, v88, v89
    v_mfma_f32_16x16x16_bf16 v[112:115], v[204:205], v[140:141], v[112:115]
    v_cvt_pk_bf16_f32 v175, v90, v91
    v_cndmask_b32 v170, v170, v221, vcc
    v_cndmask_b32 v171, v171, v225, vcc
    ds_write_b64 v243, v[172:173] offset:6144
    ds_write_b64 v243, v[174:175] offset:22528
    ds_write_b64 v244, v[170:171] offset:6144
    v_cvt_pk_bf16_f32 v8, v24, v25
    v_cvt_pk_bf16_f32 v9, v26, v27
    v_cvt_pk_bf16_f32 v10, v28, v29
    v_cvt_pk_bf16_f32 v11, v30, v31
    v_cndmask_b32 v140, v140, v209, vcc
    v_cndmask_b32 v141, v141, v225, vcc
    ds_write_b64 v243, v[8:9] offset:0
    ds_write_b64 v243, v[10:11] offset:16384
    ds_write_b64 v244, v[140:141] offset:0
    v_max3_f32 v236, v96, v97, v98
    v_mfma_f32_16x16x32_bf16 v[116:119], v[176:179], v[142:145], 0
    v_max3_f32 v237, v99, v100, v101
    v_max3_f32 v236, v236, v102, v103
    v_mfma_f32_16x16x32_bf16 v[120:123], v[180:183], v[142:145], 0
    v_max3_f32 v237, v237, v104, v105
    v_max3_f32 v236, v236, v106, v107
    v_max3_f32 v237, v237, v108, v109
    v_mfma_f32_16x16x32_bf16 v[124:127], v[184:187], v[142:145], 0
    v_max3_f32 v236, v236, v110, v111
    v_max3_f32 v237, v237, v112, v113
    v_mfma_f32_16x16x32_bf16 v[128:131], v[188:191], v[142:145], 0
    v_max3_f32 v236, v236, v114, v115
    v_max_f32 v236, v236, v237
    v_mul_f32 v236, v211, v236
    v_fma_f32 v96, v96, v211, -v236
    v_fma_f32 v97, v97, v211, -v236
    v_mfma_f32_16x16x32_bf16 v[132:135], v[192:195], v[142:145], 0
    v_fma_f32 v98, v98, v211, -v236
    v_fma_f32 v99, v99, v211, -v236
    v_mfma_f32_16x16x16_bf16 v[116:119], v[196:197], v[146:147], v[116:119]
    v_fma_f32 v100, v100, v211, -v236
    v_fma_f32 v101, v101, v211, -v236
    v_fma_f32 v102, v102, v211, -v236
    v_mfma_f32_16x16x16_bf16 v[120:123], v[198:199], v[146:147], v[120:123]
    v_fma_f32 v103, v103, v211, -v236
    v_fma_f32 v104, v104, v211, -v236
    v_fma_f32 v105, v105, v211, -v236
    v_mfma_f32_16x16x16_bf16 v[124:127], v[200:201], v[146:147], v[124:127]
    v_fma_f32 v106, v106, v211, -v236
    v_fma_f32 v107, v107, v211, -v236
    v_mfma_f32_16x16x16_bf16 v[128:131], v[202:203], v[146:147], v[128:131]
    v_fma_f32 v108, v108, v211, -v236
    v_fma_f32 v109, v109, v211, -v236
    v_fma_f32 v110, v110, v211, -v236
    v_mfma_f32_16x16x16_bf16 v[132:135], v[204:205], v[146:147], v[132:135]
    v_fma_f32 v111, v111, v211, -v236
    v_fma_f32 v112, v112, v211, -v236
    v_cvt_pk_bf16_f32 v172, v44, v45
    v_fma_f32 v113, v113, v211, -v236
    v_fma_f32 v114, v114, v211, -v236
    v_fma_f32 v115, v115, v211, -v236
    v_cvt_pk_bf16_f32 v173, v46, v47
    v_exp_f32 v96, v96
    v_exp_f32 v97, v97
    v_cvt_pk_bf16_f32 v174, v48, v49
    v_exp_f32 v98, v98
    v_exp_f32 v99, v99
    v_exp_f32 v100, v100
    v_cvt_pk_bf16_f32 v175, v50, v51
    v_exp_f32 v101, v101
    v_exp_f32 v102, v102
    v_exp_f32 v103, v103
    v_cndmask_b32 v146, v146, v213, vcc
    v_exp_f32 v104, v104
    v_exp_f32 v105, v105
    v_cndmask_b32 v147, v147, v225, vcc
    v_exp_f32 v106, v106
    v_exp_f32 v107, v107
    v_exp_f32 v108, v108
    ds_write_b64 v243, v[172:173] offset:2048
    v_exp_f32 v109, v109
    v_exp_f32 v110, v110
    ds_write_b64 v243, v[174:175] offset:18432
    v_exp_f32 v111, v111
    v_exp_f32 v112, v112
    v_exp_f32 v113, v113
    ds_write_b64 v244, v[146:147] offset:2048
    v_exp_f32 v114, v114
    v_exp_f32 v115, v115
    v_add_f32 v236, v96, v97
    v_add_f32 v237, v98, v99
    v_add_f32 v236, v236, v100
    v_add_f32 v237, v237, v101
    v_add_f32 v236, v236, v102
    v_add_f32 v237, v237, v103
    v_add_f32 v236, v236, v104
    v_add_f32 v237, v237, v105
    v_add_f32 v236, v236, v106
    v_add_f32 v237, v237, v107
    v_add_f32 v236, v236, v108
    v_add_f32 v237, v237, v109
    v_add_f32 v236, v236, v110
    v_add_f32 v237, v237, v111
    v_add_f32 v236, v236, v112
    v_add_f32 v237, v237, v113
    v_add_f32 v236, v236, v114
    v_add_f32 v237, v237, v115
    v_add_f32 v236, v236, v237
    v_rcp_f32 v236, v236
    s_nop 0
    v_mul_f32 v236, v236, v210
    v_mul_f32 v96, v96, v236
    v_mul_f32 v97, v97, v236
    v_mul_f32 v98, v98, v236
    v_mul_f32 v99, v99, v236
    v_mul_f32 v100, v100, v236
    v_mul_f32 v101, v101, v236
    v_mul_f32 v102, v102, v236
    v_mul_f32 v103, v103, v236
    v_mul_f32 v104, v104, v236
    v_mul_f32 v105, v105, v236
    v_mul_f32 v106, v106, v236
    v_mul_f32 v107, v107, v236
    v_mul_f32 v108, v108, v236
    v_mul_f32 v109, v109, v236
    v_mul_f32 v110, v110, v236
    v_mul_f32 v111, v111, v236
    v_mul_f32 v112, v112, v236
    v_mul_f32 v113, v113, v236
    v_mul_f32 v114, v114, v236
    v_mul_f32 v115, v115, v236
    v_cvt_pk_bf16_f32 v156, v96, v97
    v_cvt_pk_bf16_f32 v157, v98, v99
    v_cvt_pk_bf16_f32 v158, v100, v101
    v_cvt_pk_bf16_f32 v159, v102, v103
    ds_write_b128 v240, v[156:159] offset:0
    v_cvt_pk_bf16_f32 v160, v104, v105
    v_cvt_pk_bf16_f32 v161, v106, v107
    v_cvt_pk_bf16_f32 v162, v108, v109
    v_cvt_pk_bf16_f32 v163, v110, v111
    ds_write_b128 v241, v[160:163] offset:0
    v_cvt_pk_bf16_f32 v164, v112, v113
    v_cvt_pk_bf16_f32 v165, v114, v115
    ds_write_b64 v242, v[164:165] offset:0
    v_mov_b32 v234, v215
    v_max3_f32 v236, v116, v117, v118
    v_add_u32 v92, 158976, v7
    v_max3_f32 v237, v119, v120, v121
    v_max3_f32 v236, v236, v122, v123
    v_max3_f32 v237, v237, v124, v125
    v_max3_f32 v236, v236, v126, v127
    v_max3_f32 v237, v237, v128, v129
    v_max3_f32 v236, v236, v130, v131
    v_max3_f32 v237, v237, v132, v133
    ds_read_b128 v[28:31], v92 offset:0
    v_max3_f32 v236, v236, v134, v135
    v_max_f32 v236, v236, v237
    v_mul_f32 v235, v234, v236
    v_pk_fma_f32 v[116:117], v[116:117], v[234:235], v[234:235] op_sel:[0,0,1] op_sel_hi:[1,0,1] neg_lo:[0,0,1] neg_hi:[0,0,1]
    v_pk_fma_f32 v[118:119], v[118:119], v[234:235], v[234:235] op_sel:[0,0,1] op_sel_hi:[1,0,1] neg_lo:[0,0,1] neg_hi:[0,0,1]
    v_pk_fma_f32 v[120:121], v[120:121], v[234:235], v[234:235] op_sel:[0,0,1] op_sel_hi:[1,0,1] neg_lo:[0,0,1] neg_hi:[0,0,1]
    v_pk_fma_f32 v[122:123], v[122:123], v[234:235], v[234:235] op_sel:[0,0,1] op_sel_hi:[1,0,1] neg_lo:[0,0,1] neg_hi:[0,0,1]
    v_pk_fma_f32 v[124:125], v[124:125], v[234:235], v[234:235] op_sel:[0,0,1] op_sel_hi:[1,0,1] neg_lo:[0,0,1] neg_hi:[0,0,1]
    v_pk_fma_f32 v[126:127], v[126:127], v[234:235], v[234:235] op_sel:[0,0,1] op_sel_hi:[1,0,1] neg_lo:[0,0,1] neg_hi:[0,0,1]
    v_pk_fma_f32 v[128:129], v[128:129], v[234:235], v[234:235] op_sel:[0,0,1] op_sel_hi:[1,0,1] neg_lo:[0,0,1] neg_hi:[0,0,1]
    v_pk_fma_f32 v[130:131], v[130:131], v[234:235], v[234:235] op_sel:[0,0,1] op_sel_hi:[1,0,1] neg_lo:[0,0,1] neg_hi:[0,0,1]
    v_pk_fma_f32 v[132:133], v[132:133], v[234:235], v[234:235] op_sel:[0,0,1] op_sel_hi:[1,0,1] neg_lo:[0,0,1] neg_hi:[0,0,1]
    v_pk_fma_f32 v[134:135], v[134:135], v[234:235], v[234:235] op_sel:[0,0,1] op_sel_hi:[1,0,1] neg_lo:[0,0,1] neg_hi:[0,0,1]
    v_exp_f32 v116, v116
    v_exp_f32 v117, v117
    v_exp_f32 v118, v118
    v_exp_f32 v119, v119
    v_exp_f32 v120, v120
    v_exp_f32 v121, v121
    ds_read_b128 v[32:35], v92 offset:1024
    v_exp_f32 v122, v122
    v_exp_f32 v123, v123
    v_exp_f32 v124, v124
    v_exp_f32 v125, v125
    v_exp_f32 v126, v126
    v_exp_f32 v127, v127
    v_exp_f32 v128, v128
    ds_read_b128 v[36:39], v92 offset:2048
    v_exp_f32 v129, v129
    v_exp_f32 v130, v130
    v_exp_f32 v131, v131
    v_exp_f32 v132, v132
    v_exp_f32 v133, v133
    v_exp_f32 v134, v134
    v_exp_f32 v135, v135
    v_pk_add_f32 v[236:237], v[116:117], v[118:119]
    v_pk_add_f32 v[238:239], v[120:121], v[122:123]
    v_pk_add_f32 v[236:237], v[236:237], v[124:125]
    v_pk_add_f32 v[238:239], v[238:239], v[126:127]
    v_pk_add_f32 v[236:237], v[236:237], v[128:129]
    v_pk_add_f32 v[238:239], v[238:239], v[130:131]
    v_pk_add_f32 v[236:237], v[236:237], v[132:133]
    v_pk_add_f32 v[238:239], v[238:239], v[134:135]
    v_pk_add_f32 v[236:237], v[236:237], v[238:239]
    v_add_f32 v236, v236, v237
    v_rcp_f32 v236, v236
    s_nop 0
    v_mul_f32 v236, v236, v214
    v_pk_mul_f32 v[116:117], v[116:117], v[236:237] op_sel_hi:[1,0]
    v_pk_mul_f32 v[118:119], v[118:119], v[236:237] op_sel_hi:[1,0]
    v_pk_mul_f32 v[120:121], v[120:121], v[236:237] op_sel_hi:[1,0]
    v_pk_mul_f32 v[122:123], v[122:123], v[236:237] op_sel_hi:[1,0]
    v_pk_mul_f32 v[124:125], v[124:125], v[236:237] op_sel_hi:[1,0]
    v_pk_mul_f32 v[126:127], v[126:127], v[236:237] op_sel_hi:[1,0]
    v_pk_mul_f32 v[128:129], v[128:129], v[236:237] op_sel_hi:[1,0]
    v_pk_mul_f32 v[130:131], v[130:131], v[236:237] op_sel_hi:[1,0]
    v_pk_mul_f32 v[132:133], v[132:133], v[236:237] op_sel_hi:[1,0]
    v_pk_mul_f32 v[134:135], v[134:135], v[236:237] op_sel_hi:[1,0]
    v_cvt_pk_bf16_f32 v156, v116, v117
    v_cvt_pk_bf16_f32 v157, v118, v119
    v_cvt_pk_bf16_f32 v158, v120, v121
    v_cvt_pk_bf16_f32 v159, v122, v123
    ds_write_b128 v240, v[156:159] offset:2048
    v_cvt_pk_bf16_f32 v160, v124, v125
    v_cvt_pk_bf16_f32 v161, v126, v127
    v_cvt_pk_bf16_f32 v162, v128, v129
    v_cvt_pk_bf16_f32 v163, v130, v131
    ds_write_b128 v241, v[160:163] offset:2048
    v_cvt_pk_bf16_f32 v164, v132, v133
    v_cvt_pk_bf16_f32 v165, v134, v135
    ds_write_b64 v242, v[164:165] offset:2048
    s_mov_b64 exec, 1
    buffer_load_dword v253, off, s[16:19], s39 sc1
    s_mov_b64 exec, -1
    s_waitcnt vmcnt(0)
    buffer_load_dwordx4 v[16:19], v7, s[16:19], s38 offen sc1
    buffer_load_dwordx2 v[20:21], v1, s[16:19], s38 offen offset:1024 sc1
    buffer_load_dword v94, v255, s[16:19], 0 offen sc1
    s_setprio 1
    s_waitcnt lgkmcnt(0)
    s_barrier
    ds_read_b64_tr_b16 v[128:129], v245 offset:0
    ds_read_b64_tr_b16 v[130:131], v246 offset:512
    ds_read_b64_tr_b16 v[132:133], v247 offset:0
    ds_read_b64_tr_b16 v[134:135], v248 offset:512
    ds_read_b64_tr_b16 v[136:137], v249 offset:0
    ds_read_b64_tr_b16 v[138:139], v250 offset:512
    ds_read_b64_tr_b16 v[140:141], v245 offset:2048
    ds_read_b64_tr_b16 v[142:143], v246 offset:2560
    ds_read_b64_tr_b16 v[144:145], v247 offset:2048
    ds_read_b64_tr_b16 v[146:147], v248 offset:2560
    ds_read_b64_tr_b16 v[148:149], v249 offset:2048
    ds_read_b64_tr_b16 v[150:151], v250 offset:2560
    v_lshlrev_b32 v8, 7, v0
    v_mov_b32 v9, 1
    s_waitcnt lgkmcnt(6)
    v_mfma_f32_32x32x16_bf16 v[96:111], v[132:135], v[128:131], 0
    ds_read_b64_tr_b16 v[152:153], v245 offset:4096
    ds_read_b64_tr_b16 v[154:155], v246 offset:4608
    ds_read_b64_tr_b16 v[156:157], v247 offset:4096
    v_mfma_f32_32x32x16_bf16 v[112:127], v[136:139], v[128:131], 0
    ds_read_b64_tr_b16 v[158:159], v248 offset:4608
    ds_read_b64_tr_b16 v[160:161], v249 offset:4096
    ds_read_b64_tr_b16 v[162:163], v250 offset:4608
    s_waitcnt lgkmcnt(6)
    v_mfma_f32_32x32x16_bf16 v[96:111], v[144:147], v[140:143], v[96:111]
    ds_read_b64_tr_b16 v[128:129], v245 offset:6144
    ds_read_b64_tr_b16 v[130:131], v246 offset:6656
    ds_read_b64_tr_b16 v[132:133], v247 offset:6144
    v_mfma_f32_32x32x16_bf16 v[112:127], v[148:151], v[140:143], v[112:127]
    ds_read_b64_tr_b16 v[134:135], v248 offset:6656
    ds_read_b64_tr_b16 v[136:137], v249 offset:6144
    ds_read_b64_tr_b16 v[138:139], v250 offset:6656
    s_waitcnt lgkmcnt(6)
    v_mfma_f32_32x32x16_bf16 v[96:111], v[156:159], v[152:155], v[96:111]
    ds_read_b64_tr_b16 v[140:141], v245 offset:8192
    ds_read_b64_tr_b16 v[142:143], v246 offset:8704
    ds_read_b64_tr_b16 v[144:145], v247 offset:8192
    v_mfma_f32_32x32x16_bf16 v[112:127], v[160:163], v[152:155], v[112:127]
    ds_read_b64_tr_b16 v[146:147], v248 offset:8704
    ds_read_b64_tr_b16 v[148:149], v249 offset:8192
    ds_read_b64_tr_b16 v[150:151], v250 offset:8704
    s_mov_b64 exec, 15
    buffer_atomic_add v9, v8, s[16:19], s43 offen sc1
    s_mov_b64 exec, -1
    s_waitcnt lgkmcnt(6)
    v_mfma_f32_32x32x16_bf16 v[96:111], v[132:135], v[128:131], v[96:111]
    ds_read_b64_tr_b16 v[152:153], v245 offset:10240
    ds_read_b64_tr_b16 v[154:155], v246 offset:10752
    ds_read_b64_tr_b16 v[156:157], v247 offset:10240
    v_mfma_f32_32x32x16_bf16 v[112:127], v[136:139], v[128:131], v[112:127]
    ds_read_b64_tr_b16 v[158:159], v248 offset:10752
    ds_read_b64_tr_b16 v[160:161], v249 offset:10240
    ds_read_b64_tr_b16 v[162:163], v250 offset:10752
    s_waitcnt lgkmcnt(6)
    v_mfma_f32_32x32x16_bf16 v[96:111], v[144:147], v[140:143], v[96:111]
    ds_read_b64_tr_b16 v[128:129], v245 offset:12288
    ds_read_b64_tr_b16 v[130:131], v246 offset:12800
    ds_read_b64_tr_b16 v[132:133], v247 offset:12288
    v_mfma_f32_32x32x16_bf16 v[112:127], v[148:151], v[140:143], v[112:127]
    ds_read_b64_tr_b16 v[134:135], v248 offset:12800
    ds_read_b64_tr_b16 v[136:137], v249 offset:12288
    ds_read_b64_tr_b16 v[138:139], v250 offset:12800
    s_waitcnt lgkmcnt(6)
    v_mfma_f32_32x32x16_bf16 v[96:111], v[156:159], v[152:155], v[96:111]
    ds_read_b64_tr_b16 v[140:141], v245 offset:14336
    ds_read_b64_tr_b16 v[142:143], v246 offset:14848
    ds_read_b64_tr_b16 v[144:145], v247 offset:14336
    v_mfma_f32_32x32x16_bf16 v[112:127], v[160:163], v[152:155], v[112:127]
    ds_read_b64_tr_b16 v[146:147], v248 offset:14848
    ds_read_b64_tr_b16 v[148:149], v249 offset:14336
    ds_read_b64_tr_b16 v[150:151], v250 offset:14848
    s_waitcnt lgkmcnt(6)
    v_mfma_f32_32x32x16_bf16 v[96:111], v[132:135], v[128:131], v[96:111]
    v_mfma_f32_32x32x16_bf16 v[112:127], v[136:139], v[128:131], v[112:127]
    s_waitcnt lgkmcnt(0)
    v_mfma_f32_32x32x16_bf16 v[96:111], v[144:147], v[140:143], v[96:111]
    v_mfma_f32_32x32x16_bf16 v[112:127], v[148:151], v[140:143], v[112:127]
    s_nop 10
    v_cvt_pk_bf16_f32 v128, v96, v97
    v_cvt_pk_bf16_f32 v129, v98, v99
    v_cvt_pk_bf16_f32 v130, v100, v101
    v_cvt_pk_bf16_f32 v131, v102, v103
    buffer_store_dwordx4 v[128:131], v251, s[16:19], s62 offen sc1
    v_cvt_pk_bf16_f32 v132, v104, v105
    v_cvt_pk_bf16_f32 v133, v106, v107
    v_cvt_pk_bf16_f32 v134, v108, v109
    v_cvt_pk_bf16_f32 v135, v110, v111
    buffer_store_dwordx4 v[132:135], v251, s[16:19], s62 offen offset:672 sc1
    v_cvt_pk_bf16_f32 v136, v112, v113
    v_cvt_pk_bf16_f32 v137, v114, v115
    buffer_store_dwordx2 v[136:137], v252, s[16:19], s62 offen offset:1344 sc1
    s_setprio 0
    s_mov_b32 s70, 6144
    v_mov_b64 v[230:231], 0
    s_mov_b64 exec, 1
    buffer_load_dwordx2 v[230:231], off, s[16:19], s70 sc1
    s_mov_b64 exec, -1
    s_lshr_b32 s3, s6, 3
    s_lshl2_add_u32 s3, s5, s3
    s_lshl2_add_u32 s3, s3, s4
    s_lshl_b32 s3, s3, 6
    s_add_u32 s49, s3, 8192
    v_and_b32 v4, 15, v0
    v_lshlrev_b32 v4, 2, v4
    buffer_load_dword v229, v4, s[16:19], s49 offen sc1
    s_waitcnt vmcnt(6)
L_qchk:
    v_cmp_eq_u32 vcc, s52, v253
    s_cbranch_vccnz L_qlate
L_phi:
    v_mfma_f32_32x32x16_bf16 v[40:55], v[28:31], v[16:19], 0
    v_mfma_f32_32x32x8_bf16 v[40:55], v[36:37], v[20:21], v[40:55]
    v_mfma_f32_32x32x16_bf16 v[56:71], v[32:35], v[16:19], 0
    v_mfma_f32_32x32x8_bf16 v[56:71], v[38:39], v[20:21], v[56:71]
    s_setprio 0
    v_and_b32 v94, 0xffff0000, v94
    v_rcp_f32 v94, v94
    s_nop 0
    v_mul_f32 v94, 0x3fb8aa3b, v94
    s_mov_b32 s55, 0
    s_add_u32 s54, s40, 3584
    s_cmp_eq_u32 s4, 7
    s_nop 1
    v_max3_f32 v92, v40, v41, v42
    v_max3_f32 v93, v43, v44, v45
    v_max3_f32 v92, v92, v46, v47
    v_max3_f32 v93, v93, v48, v49
    v_max3_f32 v92, v92, v50, v51
    v_max3_f32 v93, v93, v52, v53
    v_max3_f32 v92, v92, v54, v55
    v_max3_f32 v93, v93, v56, v57
    v_max3_f32 v92, v92, v58, v59
    v_max_f32 v92, v92, v93
    v_mul_f32 v92, v94, v92
    v_fma_f32 v40, v40, v94, -v92
    v_fma_f32 v41, v41, v94, -v92
    v_fma_f32 v42, v42, v94, -v92
    v_fma_f32 v43, v43, v94, -v92
    v_fma_f32 v44, v44, v94, -v92
    v_fma_f32 v45, v45, v94, -v92
    v_fma_f32 v46, v46, v94, -v92
    v_fma_f32 v47, v47, v94, -v92
    v_fma_f32 v48, v48, v94, -v92
    v_fma_f32 v49, v49, v94, -v92
    v_fma_f32 v50, v50, v94, -v92
    v_fma_f32 v51, v51, v94, -v92
    v_fma_f32 v52, v52, v94, -v92
    v_fma_f32 v53, v53, v94, -v92
    v_fma_f32 v54, v54, v94, -v92
    v_fma_f32 v55, v55, v94, -v92
    v_fma_f32 v56, v56, v94, -v92
    v_fma_f32 v57, v57, v94, -v92
    v_fma_f32 v58, v58, v94, -v92
    v_fma_f32 v59, v59, v94, -v92
    v_exp_f32 v40, v40
    v_exp_f32 v41, v41
    v_exp_f32 v42, v42
    v_exp_f32 v43, v43
    v_exp_f32 v44, v44
    v_exp_f32 v45, v45
    v_exp_f32 v46, v46
    v_exp_f32 v47, v47
    v_exp_f32 v48, v48
    v_exp_f32 v49, v49
    v_exp_f32 v50, v50
    v_exp_f32 v51, v51
    v_exp_f32 v52, v52
    v_exp_f32 v53, v53
    v_exp_f32 v54, v54
    v_exp_f32 v55, v55
    v_exp_f32 v56, v56
    v_exp_f32 v57, v57
    v_exp_f32 v58, v58
    s_cbranch_scc0 L_hs
    s_mov_b64 exec, 1
    v_mov_b32 v18, 0
    buffer_atomic_or v18, v0, s[16:19], s44 offen sc0 sc1
    s_mov_b64 exec, -1
L_hs:
    v_exp_f32 v59, v59
    v_add_f32 v92, v40, v41
    v_add_f32 v93, v42, v43
    v_add_f32 v92, v92, v44
    v_add_f32 v93, v93, v45
    v_add_f32 v92, v92, v46
    v_add_f32 v93, v93, v47
    v_add_f32 v92, v92, v48
    v_add_f32 v93, v93, v49
    v_add_f32 v92, v92, v50
    v_add_f32 v93, v93, v51
    v_add_f32 v92, v92, v52
    v_add_f32 v93, v93, v53
    v_add_f32 v92, v92, v54
    v_add_f32 v93, v93, v55
    v_add_f32 v92, v92, v56
    v_add_f32 v93, v93, v57
    v_add_f32 v92, v92, v58
    v_add_f32 v93, v93, v59
    v_add_f32 v92, v92, v93
    v_rcp_f32 v92, v92
    s_nop 0
    v_mul_f32 v40, v40, v92
    v_mul_f32 v41, v41, v92
    v_mul_f32 v42, v42, v92
    v_mul_f32 v43, v43, v92
    v_mul_f32 v44, v44, v92
    v_mul_f32 v45, v45, v92
    v_mul_f32 v46, v46, v92
    v_mul_f32 v47, v47, v92
    v_mul_f32 v48, v48, v92
    v_mul_f32 v49, v49, v92
    v_mul_f32 v50, v50, v92
    v_mul_f32 v51, v51, v92
    v_mul_f32 v52, v52, v92
    v_mul_f32 v53, v53, v92
    v_mul_f32 v54, v54, v92
    v_mul_f32 v55, v55, v92
    v_mul_f32 v56, v56, v92
    v_mul_f32 v57, v57, v92
    v_mul_f32 v58, v58, v92
    v_mul_f32 v59, v59, v92
    v_cvt_pk_bf16_f32 v72, v40, v41
    v_cvt_pk_bf16_f32 v73, v42, v43
    v_cvt_pk_bf16_f32 v74, v44, v45
    v_cvt_pk_bf16_f32 v75, v46, v47
    v_cvt_pk_bf16_f32 v76, v48, v49
    v_cvt_pk_bf16_f32 v77, v50, v51
    v_cvt_pk_bf16_f32 v78, v52, v53
    v_cvt_pk_bf16_f32 v79, v54, v55
    v_cvt_pk_bf16_f32 v80, v56, v57
    v_cvt_pk_bf16_f32 v81, v58, v59
    s_cbranch_scc1 L_phix
L_kvwait:
    s_barrier
L_kfull:
    buffer_load_dwordx4 v[40:43], v15, s[16:19], s40 offen offset:0 sc1
    buffer_load_dwordx4 v[44:47], v15, s[16:19], s40 offen offset:1792 sc1
    buffer_load_dwordx4 v[48:51], v15, s[16:19], s54 offen offset:0 sc1
    buffer_load_dwordx4 v[52:55], v15, s[16:19], s54 offen offset:1792 sc1
    v_and_b32 v16, 1, v0
    v_lshlrev_b32 v16, 4, v16
    s_movk_i32 s3, 0x3f80
    v_lshlrev_b32 v16, v16, s3
    v_bfe_u32 v17, v0, 1, 2
    v_cmp_eq_u32 vcc, 0, v17
    s_nop 1
    v_cndmask_b32 v24, 0, v16, vcc
    v_cmp_eq_u32 vcc, 1, v17
    s_nop 1
    v_cndmask_b32 v25, 0, v16, vcc
    v_cmp_eq_u32 vcc, 2, v17
    s_nop 1
    v_cndmask_b32 v26, 0, v16, vcc
    v_cmp_eq_u32 vcc, 3, v17
    s_nop 1
    v_cndmask_b32 v27, 0, v16, vcc
    v_and_b32 v56, 31, v0
    v_min_u32 v56, 20, v56
    v_lshrrev_b32 v57, 5, v0
    v_mov_b32 v58, 0x7ff00000
    v_mul_u32_u24 v59, 21, v57
    v_add_u32 v56, v56, v59
    s_mov_b32 s3, 156928
    v_lshl_add_u32 v23, v56, 3, s3
    v_lshl_add_u32 v22, v56, 4, s3
    v_bfe_u32 v12, v0, 4, 1
    v_mul_u32_u24 v12, 20480, v12
    v_and_b32 v56, 15, v0
    v_cmp_gt_u32 vcc, 32, v0
    v_lshl_add_u32 v13, v56, 3, v12
    v_lshl_add_u32 v12, v56, 4, v12
    v_lshl_add_u32 v12, v57, 8, v12
    v_cndmask_b32 v13, v58, v13, vcc
    s_cmp_lt_u32 s4, 4
    s_cbranch_scc1 L_fs0
    s_lshr_b32 s3, s6, 3
    s_lshl3_add_u32 s50, s5, s3
    s_lshl_b32 s50, s50, 7
    s_add_u32 s50, s50, 57344
    s_lshl2_add_u32 s3, s5, s3
    s_and_b32 s53, s4, 3
    s_lshl2_add_u32 s51, s3, s53
    s_mul_i32 s48, s51, 20480
    s_add_u32 s45, s48, 4268032
    s_add_u32 s46, s45, 4096
    s_add_u32 s47, s48, 4278272
    s_and_b32 s3, s6, 7
    s_mul_i32 s3, s3, 160
    s_add_u32 s48, s48, s3
    v_lshlrev_b32 v7, 4, v0
    v_lshrrev_b32 v56, 4, v0
    v_bfe_u32 v57, v0, 2, 2
    v_and_b32 v58, 3, v0
    v_mul_u32_u24 v57, 160, v57
    v_lshl_add_u32 v57, v58, 3, v57
    v_add_u32 v57, 51200, v57
    v_lshrrev_b32 v58, 5, v0
    v_mul_u32_u24 v58, 3200, v58
    v_and_b32 v6, 1, v56
    v_mul_u32_u24 v6, 640, v6
    v_add3_u32 v6, v6, v58, v57
    v_mul_u32_u24 v2, 3200, v56
    v_add_u32 v2, v2, v57
    s_mul_i32 s3, s53, 2560
    s_add_u32 s3, s3, 133120
    v_and_b32 v57, 15, v0
    v_mul_u32_u24 v3, 160, v57
    v_lshl_add_u32 v3, v56, 3, v3
    v_add_u32 v3, s3, v3
    v_add_u32 v11, s3, v7
    s_mul_i32 s3, s53, 5120
    s_add_u32 s3, s3, 112640
    v_add_u32 v5, s3, v7
    v_mul_u32_u24 v56, 6554, v0
    s_movk_i32 s3, 1120
    v_cmp_gt_u32 vcc, 32, v0
    v_lshrrev_b32 v57, 16, v56
    v_mad_u32_u24 v8, v57, s3, v7
    v_add_u32 v56, 419456, v56
    v_lshrrev_b32 v57, 16, v56
    v_mad_u32_u24 v9, v57, s3, v7
    v_add_u32 v56, 419456, v56
    v_lshrrev_b32 v57, 16, v56
    v_mad_u32_u24 v10, v57, s3, v7
    v_mov_b32 v56, 0x7ff00000
    v_cndmask_b32 v10, v56, v10, vcc
    s_branch L_fs1
L_fs0:
    s_lshr_b32 s3, s6, 3
    s_lshl3_add_u32 s50, s5, s3
    s_lshl_b32 s50, s50, 7
    s_add_u32 s50, s50, 57344
    s_lshl2_add_u32 s3, s5, s3
    s_and_b32 s53, s4, 3
    s_lshl2_add_u32 s51, s3, s53
    s_mul_i32 s48, s51, 20480
    s_add_u32 s45, s48, 4259840
    s_add_u32 s46, s45, 4096
    s_add_u32 s47, s48, 4276224
    s_and_b32 s3, s6, 7
    s_mul_i32 s3, s3, 160
    s_add_u32 s48, s48, s3
    s_lshl_b32 s49, s51, 6
    s_add_u32 s49, s49, 8192
    v_lshlrev_b32 v7, 4, v0
    v_lshrrev_b32 v56, 4, v0
    v_bfe_u32 v57, v0, 2, 2
    v_and_b32 v58, 3, v0
    v_mul_u32_u24 v57, 160, v57
    v_lshl_add_u32 v57, v58, 3, v57
    v_lshrrev_b32 v58, 5, v0
    v_mul_u32_u24 v58, 3200, v58
    v_and_b32 v6, 1, v56
    v_mul_u32_u24 v6, 640, v6
    v_add3_u32 v6, v6, v58, v57
    v_mul_u32_u24 v2, 3200, v56
    v_add_u32 v2, v2, v57
    s_mul_i32 s3, s53, 2560
    s_add_u32 s3, s3, 102400
    v_and_b32 v57, 15, v0
    v_mul_u32_u24 v3, 160, v57
    v_lshl_add_u32 v3, v56, 3, v3
    v_add_u32 v3, s3, v3
    v_lshlrev_b32 v4, 2, v57
    s_mul_i32 s3, s53, 5120
    s_add_u32 s3, s3, 112640
    v_add_u32 v5, s3, v7
    s_waitcnt vmcnt(4)
    v_max_u32 v92, v230, v231
    v_cmp_eq_u32 vcc, s52, v92
    s_cbranch_vccz L_ok_16
    s_mov_b32 s3, 0
L_poll_17:
    s_add_u32 s3, s3, 1
    s_cmp_gt_u32 s3, 200000
    s_cbranch_scc1 L_pdone_19
    s_sleep 8
    s_mov_b32 s70, 6144
    v_mov_b64 v[230:231], 0
    s_mov_b64 exec, 1
    buffer_load_dwordx2 v[230:231], off, s[16:19], s70 sc1
    s_mov_b64 exec, -1
L_chk_18:
    s_waitcnt vmcnt(0)
    v_max_u32 v92, v230, v231
    v_cmp_eq_u32 vcc, s52, v92
    s_cbranch_vccnz L_poll_17
L_pdone_19:
L_ok_16:
    v_readfirstlane_b32 s100, v230
    v_readfirstlane_b32 s101, v231
    v_mov_b32 v56, v229
    v_cmp_eq_u32 vcc, s52, v56
    s_cbranch_vccz L_ok_20
    s_mov_b32 s3, 0
L_poll_21:
    s_add_u32 s3, s3, 1
    s_cmp_gt_u32 s3, 200000
    s_cbranch_scc1 L_pdone_23
    buffer_load_dword v229, v4, s[16:19], s49 offen sc1
L_chk_22:
    s_waitcnt vmcnt(0)
    v_mov_b32 v56, v229
    v_cmp_eq_u32 vcc, s52, v56
    s_cbranch_vccnz L_poll_21
L_pdone_23:
L_ok_20:
    v_and_b32 v8, 0xffff0000, v229
    v_rcp_f32 v8, v8
    v_lshlrev_b32 v9, 16, v229
    s_not_b32 s3, s100
    s_bfe_u32 s3, s3, 0x70004
    s_cmp_eq_u32 s3, s51
    s_cselect_b32 s61, 1, 0
    v_mul_f32 v9, v9, v8
    v_add_f32 v8, 1.0, v8
    s_not_b32 s3, s101
    s_bfe_u32 s3, s3, 0x70004
    s_cmp_eq_u32 s3, s51
    s_cselect_b32 s3, 2, 0
    s_or_b32 s61, s61, s3
L_fs1:
    s_waitcnt vmcnt(3)
    v_mfma_f32_16x16x32_bf16 v[16:19], v[24:27], v[40:43], 0
    v_max3_u32 v92, v40, v41, v40
    v_max3_u32 v92, v92, v42, v43
    s_waitcnt vmcnt(2)
    v_mfma_f32_16x16x32_bf16 v[16:19], v[24:27], v[44:47], v[16:19]
    v_max3_u32 v92, v44, v45, v92
    v_max3_u32 v92, v92, v46, v47
    s_waitcnt vmcnt(1)
    v_mfma_f32_16x16x32_bf16 v[16:19], v[24:27], v[48:51], v[16:19]
    v_max3_u32 v92, v48, v49, v92
    v_max3_u32 v92, v92, v50, v51
    s_waitcnt vmcnt(0)
    v_mfma_f32_16x16x32_bf16 v[16:19], v[24:27], v[52:55], v[16:19]
    v_max3_u32 v92, v52, v53, v92
    v_max3_u32 v92, v92, v54, v55
    v_cmp_eq_u32 vcc, s52, v92
    s_cbranch_vccnz L_kagain
    s_nop 3
    v_cvt_pk_bf16_f32 v16, v16, v17
    v_cvt_pk_bf16_f32 v17, v18, v19
    ds_write_b64 v14, v[16:17]
L_kred:
    s_waitcnt lgkmcnt(0)
    s_barrier
    ds_read_b128 v[28:31], v22
    ds_read_b128 v[32:35], v22 offset:672
    ds_read_b64 v[36:37], v23 offset:1344
    s_cmp_eq_u32 s4, 7
    s_cbranch_scc0 L_oh_24
    s_mov_b64 exec, s[54:55]
    buffer_atomic_add v15, v14, s[16:19], s43 offen sc1
    s_mov_b64 exec, -1
L_oh_24:
    s_cmp_lt_u32 s57, 8
    s_cbranch_scc0 L_o2
    s_waitcnt lgkmcnt(2)
    v_mfma_f32_32x32x16_bf16 v[40:55], v[28:31], v[72:75], 0
    s_waitcnt lgkmcnt(1)
    v_mfma_f32_32x32x16_bf16 v[40:55], v[32:35], v[76:79], v[40:55]
    s_waitcnt lgkmcnt(0)
    v_mfma_f32_32x32x8_bf16 v[40:55], v[36:37], v[80:81], v[40:55]
L_o1:
    s_nop 11
    v_add_f32 v16, 0x358637bd, v52
    v_rcp_f32 v16, v16
    s_nop 0
    v_mul_f32 v40, v40, v16
    v_mul_f32 v41, v41, v16
    v_mul_f32 v42, v42, v16
    v_mul_f32 v43, v43, v16
    v_mul_f32 v44, v44, v16
    v_mul_f32 v45, v45, v16
    v_mul_f32 v46, v46, v16
    v_mul_f32 v47, v47, v16
    v_cvt_pk_bf16_f32 v18, v40, v41
    v_cvt_pk_bf16_f32 v19, v42, v43
    v_cvt_pk_bf16_f32 v20, v44, v45
    v_cvt_pk_bf16_f32 v21, v46, v47
    buffer_store_dwordx4 v[18:21], v12, s[16:19], s41 offen sc1
    v_mul_f32 v48, v48, v16
    v_mul_f32 v49, v49, v16
    v_mul_f32 v50, v50, v16
    v_mul_f32 v51, v51, v16
    v_cvt_pk_bf16_f32 v22, v48, v49
    v_cvt_pk_bf16_f32 v23, v50, v51
    buffer_store_dwordx2 v[22:23], v13, s[16:19], s42 offen sc1
L_final:
    v_lshlrev_b32 v1, 3, v0
    s_mov_b32 s63, 0
    s_cmp_lt_u32 s4, 4
    s_cbranch_scc0 L_c2
L_c1:
    s_cmp_eq_u32 s61, 0
    s_cbranch_scc0 L_y0
L_y1:
    ds_read_b64_tr_b16 v[76:77], v6 offset:0
    ds_read_b64_tr_b16 v[78:79], v6 offset:1280
    ds_read_b64_tr_b16 v[80:81], v6 offset:32
    ds_read_b64_tr_b16 v[82:83], v6 offset:1312
    ds_read_b64_tr_b16 v[84:85], v6 offset:64
    ds_read_b64_tr_b16 v[86:87], v6 offset:1344
    ds_read_b64_tr_b16 v[88:89], v6 offset:96
    ds_read_b64_tr_b16 v[90:91], v6 offset:1376
    ds_read_b64_tr_b16 v[92:93], v6 offset:128
    ds_read_b64_tr_b16 v[94:95], v6 offset:1408
    ds_read_b64_tr_b16 v[96:97], v6 offset:6400
    ds_read_b64_tr_b16 v[98:99], v6 offset:7680
    ds_read_b64_tr_b16 v[100:101], v6 offset:6432
    ds_read_b64_tr_b16 v[102:103], v6 offset:7712
    ds_read_b64_tr_b16 v[104:105], v6 offset:6464
    ds_read_b64_tr_b16 v[106:107], v6 offset:7744
    ds_read_b64_tr_b16 v[108:109], v6 offset:6496
    ds_read_b64_tr_b16 v[110:111], v6 offset:7776
    ds_read_b64_tr_b16 v[112:113], v6 offset:6528
    ds_read_b64_tr_b16 v[114:115], v6 offset:7808
    ds_read_b64_tr_b16 v[116:117], v6 offset:12800
    ds_read_b64_tr_b16 v[118:119], v6 offset:14080
    ds_read_b64_tr_b16 v[120:121], v6 offset:12832
    ds_read_b64_tr_b16 v[122:123], v6 offset:14112
    ds_read_b64_tr_b16 v[124:125], v6 offset:12864
    ds_read_b64_tr_b16 v[126:127], v6 offset:14144
    ds_read_b64_tr_b16 v[128:129], v6 offset:12896
    ds_read_b64_tr_b16 v[130:131], v6 offset:14176
    ds_read_b64_tr_b16 v[132:133], v6 offset:12928
    ds_read_b64_tr_b16 v[134:135], v6 offset:14208
    ds_read_b64_tr_b16 v[136:137], v6 offset:19200
    ds_read_b64_tr_b16 v[138:139], v6 offset:20480
    ds_read_b64_tr_b16 v[140:141], v6 offset:19232
    ds_read_b64_tr_b16 v[142:143], v6 offset:20512
    ds_read_b64_tr_b16 v[144:145], v6 offset:19264
    ds_read_b64_tr_b16 v[146:147], v6 offset:20544
    ds_read_b64_tr_b16 v[148:149], v6 offset:19296
    ds_read_b64_tr_b16 v[150:151], v6 offset:20576
    ds_read_b64_tr_b16 v[152:153], v6 offset:19328
    ds_read_b64_tr_b16 v[154:155], v6 offset:20608
    ds_read_b64_tr_b16 v[156:157], v6 offset:25600
    ds_read_b64_tr_b16 v[158:159], v6 offset:26880
    ds_read_b64_tr_b16 v[160:161], v6 offset:25632
    ds_read_b64_tr_b16 v[162:163], v6 offset:26912
    ds_read_b64_tr_b16 v[164:165], v6 offset:25664
    ds_read_b64_tr_b16 v[166:167], v6 offset:26944
    ds_read_b64_tr_b16 v[168:169], v6 offset:25696
    ds_read_b64_tr_b16 v[170:171], v6 offset:26976
    ds_read_b64_tr_b16 v[172:173], v6 offset:25728
    ds_read_b64_tr_b16 v[174:175], v6 offset:27008
    ds_read_b64_tr_b16 v[176:177], v6 offset:32000
    ds_read_b64_tr_b16 v[178:179], v6 offset:33280
    ds_read_b64_tr_b16 v[180:181], v6 offset:32032
    ds_read_b64_tr_b16 v[182:183], v6 offset:33312
    ds_read_b64_tr_b16 v[184:185], v6 offset:32064
    ds_read_b64_tr_b16 v[186:187], v6 offset:33344
    ds_read_b64_tr_b16 v[188:189], v6 offset:32096
    ds_read_b64_tr_b16 v[190:191], v6 offset:33376
    ds_read_b64_tr_b16 v[192:193], v6 offset:32128
    ds_read_b64_tr_b16 v[194:195], v6 offset:33408
    s_cmp_eq_u32 s61, 0
    s_cbranch_scc0 L_y4
L_y5:
    s_barrier
    buffer_load_dwordx4 v[36:39], v7, s[16:19], s45 offen offset:0 sc1
    buffer_load_dwordx4 v[40:43], v7, s[16:19], s45 offen offset:1024 sc1
    buffer_load_dwordx4 v[44:47], v7, s[16:19], s45 offen offset:2048 sc1
    buffer_load_dwordx4 v[48:51], v7, s[16:19], s45 offen offset:3072 sc1
    ds_read_b64 v[246:247], v3 offset:0
    ds_read_b64 v[248:249], v3 offset:32
    ds_read_b64 v[250:251], v3 offset:64
    ds_read_b64 v[252:253], v3 offset:96
    ds_read_b64 v[254:255], v3 offset:128
    ds_read_b64_tr_b16 v[196:197], v6 offset:38400
    ds_read_b64_tr_b16 v[198:199], v6 offset:39680
    ds_read_b64_tr_b16 v[200:201], v6 offset:38432
    ds_read_b64_tr_b16 v[202:203], v6 offset:39712
    ds_read_b64_tr_b16 v[204:205], v6 offset:38464
    ds_read_b64_tr_b16 v[206:207], v6 offset:39744
    ds_read_b64_tr_b16 v[208:209], v6 offset:38496
    ds_read_b64_tr_b16 v[210:211], v6 offset:39776
    ds_read_b64_tr_b16 v[212:213], v6 offset:38528
    ds_read_b64_tr_b16 v[214:215], v6 offset:39808
    ds_read_b64_tr_b16 v[216:217], v6 offset:44800
    ds_read_b64_tr_b16 v[218:219], v6 offset:46080
    ds_read_b64_tr_b16 v[220:221], v6 offset:44832
    ds_read_b64_tr_b16 v[222:223], v6 offset:46112
    ds_read_b64_tr_b16 v[224:225], v6 offset:44864
    ds_read_b64_tr_b16 v[226:227], v6 offset:46144
    ds_read_b64_tr_b16 v[228:229], v6 offset:44896
    ds_read_b64_tr_b16 v[230:231], v6 offset:46176
    ds_read_b64_tr_b16 v[232:233], v6 offset:44928
    ds_read_b64_tr_b16 v[234:235], v6 offset:46208
    s_cmp_eq_u32 s61, 0
    s_waitcnt lgkmcnt(14)
    v_lshlrev_b32 v236, 16, v246
    v_and_b32 v237, 0xffff0000, v246
    v_lshlrev_b32 v238, 16, v247
    v_and_b32 v239, 0xffff0000, v247
    v_lshlrev_b32 v240, 16, v248
    v_and_b32 v241, 0xffff0000, v248
    v_lshlrev_b32 v242, 16, v249
    v_and_b32 v243, 0xffff0000, v249
    v_lshlrev_b32 v244, 16, v250
    v_and_b32 v245, 0xffff0000, v250
    v_lshlrev_b32 v246, 16, v251
    v_and_b32 v247, 0xffff0000, v251
    v_lshlrev_b32 v248, 16, v252
    v_and_b32 v249, 0xffff0000, v252
    v_lshlrev_b32 v250, 16, v253
    v_and_b32 v251, 0xffff0000, v253
    v_lshlrev_b32 v252, 16, v254
    v_and_b32 v253, 0xffff0000, v254
    v_lshlrev_b32 v254, 16, v255
    v_and_b32 v255, 0xffff0000, v255
    v_pk_fma_f32 v[16:17], v[236:237], v[8:9], v[8:9] op_sel:[0,0,1] op_sel_hi:[1,0,1] neg_lo:[0,0,1] neg_hi:[0,0,1]
    v_pk_fma_f32 v[18:19], v[238:239], v[8:9], v[8:9] op_sel:[0,0,1] op_sel_hi:[1,0,1] neg_lo:[0,0,1] neg_hi:[0,0,1]
    v_pk_fma_f32 v[20:21], v[240:241], v[8:9], v[8:9] op_sel:[0,0,1] op_sel_hi:[1,0,1] neg_lo:[0,0,1] neg_hi:[0,0,1]
    v_pk_fma_f32 v[22:23], v[242:243], v[8:9], v[8:9] op_sel:[0,0,1] op_sel_hi:[1,0,1] neg_lo:[0,0,1] neg_hi:[0,0,1]
    v_pk_fma_f32 v[24:25], v[244:245], v[8:9], v[8:9] op_sel:[0,0,1] op_sel_hi:[1,0,1] neg_lo:[0,0,1] neg_hi:[0,0,1]
    v_pk_fma_f32 v[26:27], v[246:247], v[8:9], v[8:9] op_sel:[0,0,1] op_sel_hi:[1,0,1] neg_lo:[0,0,1] neg_hi:[0,0,1]
    v_pk_fma_f32 v[28:29], v[248:249], v[8:9], v[8:9] op_sel:[0,0,1] op_sel_hi:[1,0,1] neg_lo:[0,0,1] neg_hi:[0,0,1]
    v_pk_fma_f32 v[30:31], v[250:251], v[8:9], v[8:9] op_sel:[0,0,1] op_sel_hi:[1,0,1] neg_lo:[0,0,1] neg_hi:[0,0,1]
    v_pk_fma_f32 v[32:33], v[252:253], v[8:9], v[8:9] op_sel:[0,0,1] op_sel_hi:[1,0,1] neg_lo:[0,0,1] neg_hi:[0,0,1]
    v_pk_fma_f32 v[34:35], v[254:255], v[8:9], v[8:9] op_sel:[0,0,1] op_sel_hi:[1,0,1] neg_lo:[0,0,1] neg_hi:[0,0,1]
    ds_read_b64_tr_b16 v[236:237], v2 offset:2560
    ds_read_b64_tr_b16 v[238:239], v2 offset:15360
    ds_read_b64_tr_b16 v[240:241], v2 offset:2592
    ds_read_b64_tr_b16 v[242:243], v2 offset:15392
    ds_read_b64_tr_b16 v[244:245], v2 offset:2624
    ds_read_b64_tr_b16 v[246:247], v2 offset:15424
    ds_read_b64_tr_b16 v[248:249], v2 offset:2656
    ds_read_b64_tr_b16 v[250:251], v2 offset:15456
    ds_read_b64_tr_b16 v[252:253], v2 offset:2688
    ds_read_b64_tr_b16 v[254:255], v2 offset:15488
    s_cbranch_scc0 L_y2
L_y3:
    s_waitcnt lgkmcnt(10)
    s_waitcnt vmcnt(2)
    v_max3_u32 v13, v36, v37, v38
    v_max3_u32 v12, v39, v40, v41
    v_max3_u32 v13, v13, v42, v43
    v_max_u32 v13, v13, v12
    v_cmp_eq_u32 vcc, s52, v13
    s_cbranch_vccnz L_oretry
L_og0:
    v_mfma_f32_16x16x32_bf16 v[16:19], v[76:79], v[36:39], v[16:19]
    buffer_load_dwordx4 v[52:55], v7, s[16:19], s46 offen offset:0 sc1
    v_mfma_f32_16x16x32_bf16 v[20:23], v[80:83], v[36:39], v[20:23]
    buffer_load_dwordx4 v[56:59], v7, s[16:19], s46 offen offset:1024 sc1
    v_mfma_f32_16x16x32_bf16 v[24:27], v[84:87], v[36:39], v[24:27]
    v_mfma_f32_16x16x32_bf16 v[28:31], v[88:91], v[36:39], v[28:31]
    v_mfma_f32_16x16x32_bf16 v[32:35], v[92:95], v[36:39], v[32:35]
    s_mov_b32 s63, 1
    v_mfma_f32_16x16x32_bf16 v[16:19], v[96:99], v[40:43], v[16:19]
    s_waitcnt vmcnt(2)
    v_max3_u32 v13, v44, v45, v46
    v_mfma_f32_16x16x32_bf16 v[20:23], v[100:103], v[40:43], v[20:23]
    v_max3_u32 v12, v47, v48, v49
    v_mfma_f32_16x16x32_bf16 v[24:27], v[104:107], v[40:43], v[24:27]
    v_max3_u32 v13, v13, v50, v51
    v_mfma_f32_16x16x32_bf16 v[28:31], v[108:111], v[40:43], v[28:31]
    v_max_u32 v13, v13, v12
    v_mfma_f32_16x16x32_bf16 v[32:35], v[112:115], v[40:43], v[32:35]
    v_cmp_eq_u32 vcc, s52, v13
    s_cbranch_vccnz L_oretry
L_og1:
    s_waitcnt lgkmcnt(0)
    v_mfma_f32_16x16x32_bf16 v[16:19], v[116:119], v[44:47], v[16:19]
    buffer_load_dwordx4 v[60:63], v7, s[16:19], s46 offen offset:2048 sc1
    ds_read_b64_tr_b16 v[76:77], v2 offset:28160
    v_mfma_f32_16x16x32_bf16 v[20:23], v[120:123], v[44:47], v[20:23]
    buffer_load_dwordx4 v[64:67], v7, s[16:19], s46 offen offset:3072 sc1
    ds_read_b64_tr_b16 v[78:79], v2 offset:40960
    v_mfma_f32_16x16x32_bf16 v[24:27], v[124:127], v[44:47], v[24:27]
    ds_read_b64_tr_b16 v[80:81], v2 offset:28192
    v_mfma_f32_16x16x32_bf16 v[28:31], v[128:131], v[44:47], v[28:31]
    ds_read_b64_tr_b16 v[82:83], v2 offset:40992
    v_mfma_f32_16x16x32_bf16 v[32:35], v[132:135], v[44:47], v[32:35]
    ds_read_b64_tr_b16 v[84:85], v2 offset:28224
    s_mov_b32 s63, 2
    v_mfma_f32_16x16x32_bf16 v[16:19], v[136:139], v[48:51], v[16:19]
    s_waitcnt vmcnt(2)
    v_max3_u32 v13, v52, v53, v54
    v_mfma_f32_16x16x32_bf16 v[20:23], v[140:143], v[48:51], v[20:23]
    v_max3_u32 v12, v55, v56, v57
    v_mfma_f32_16x16x32_bf16 v[24:27], v[144:147], v[48:51], v[24:27]
    v_max3_u32 v13, v13, v58, v59
    v_mfma_f32_16x16x32_bf16 v[28:31], v[148:151], v[48:51], v[28:31]
    v_max_u32 v13, v13, v12
    v_mfma_f32_16x16x32_bf16 v[32:35], v[152:155], v[48:51], v[32:35]
    v_cmp_eq_u32 vcc, s52, v13
    s_cbranch_vccnz L_oretry
L_og2:
    v_mfma_f32_16x16x32_bf16 v[16:19], v[156:159], v[52:55], v[16:19]
    buffer_load_dwordx2 v[68:69], v1, s[16:19], s47 offen offset:0 sc1
    ds_read_b64_tr_b16 v[86:87], v2 offset:41024
    v_mfma_f32_16x16x32_bf16 v[20:23], v[160:163], v[52:55], v[20:23]
    buffer_load_dwordx2 v[70:71], v1, s[16:19], s47 offen offset:512 sc1
    ds_read_b64_tr_b16 v[88:89], v2 offset:28256
    v_mfma_f32_16x16x32_bf16 v[24:27], v[164:167], v[52:55], v[24:27]
    buffer_load_dwordx2 v[72:73], v1, s[16:19], s47 offen offset:1024 sc1
    ds_read_b64_tr_b16 v[90:91], v2 offset:41056
    v_mfma_f32_16x16x32_bf16 v[28:31], v[168:171], v[52:55], v[28:31]
    buffer_load_dwordx2 v[74:75], v1, s[16:19], s47 offen offset:1536 sc1
    ds_read_b64_tr_b16 v[92:93], v2 offset:28288
    v_mfma_f32_16x16x32_bf16 v[32:35], v[172:175], v[52:55], v[32:35]
    ds_read_b64_tr_b16 v[94:95], v2 offset:41088
    s_mov_b32 s63, 3
    v_mfma_f32_16x16x32_bf16 v[16:19], v[176:179], v[56:59], v[16:19]
    s_waitcnt vmcnt(4)
    v_max3_u32 v13, v60, v61, v62
    v_mfma_f32_16x16x32_bf16 v[20:23], v[180:183], v[56:59], v[20:23]
    v_max3_u32 v12, v63, v64, v65
    v_mfma_f32_16x16x32_bf16 v[24:27], v[184:187], v[56:59], v[24:27]
    v_max3_u32 v13, v13, v66, v67
    v_mfma_f32_16x16x32_bf16 v[28:31], v[188:191], v[56:59], v[28:31]
    v_max_u32 v13, v13, v12
    v_mfma_f32_16x16x32_bf16 v[32:35], v[192:195], v[56:59], v[32:35]
    v_cmp_eq_u32 vcc, s52, v13
    s_cbranch_vccnz L_oretry
L_og3:
    v_mfma_f32_16x16x32_bf16 v[16:19], v[196:199], v[60:63], v[16:19]
    v_mfma_f32_16x16x32_bf16 v[20:23], v[200:203], v[60:63], v[20:23]
    v_mfma_f32_16x16x32_bf16 v[24:27], v[204:207], v[60:63], v[24:27]
    v_mfma_f32_16x16x32_bf16 v[28:31], v[208:211], v[60:63], v[28:31]
    v_mfma_f32_16x16x32_bf16 v[32:35], v[212:215], v[60:63], v[32:35]
    s_mov_b32 s63, 4
    v_mfma_f32_16x16x32_bf16 v[16:19], v[216:219], v[64:67], v[16:19]
    s_waitcnt vmcnt(0)
    v_max3_u32 v13, v68, v69, v70
    v_mfma_f32_16x16x32_bf16 v[20:23], v[220:223], v[64:67], v[20:23]
    v_max3_u32 v12, v71, v72, v73
    v_mfma_f32_16x16x32_bf16 v[24:27], v[224:227], v[64:67], v[24:27]
    v_max3_u32 v13, v13, v74, v75
    v_mfma_f32_16x16x32_bf16 v[28:31], v[228:231], v[64:67], v[28:31]
    v_max_u32 v13, v13, v12
    v_mfma_f32_16x16x32_bf16 v[32:35], v[232:235], v[64:67], v[32:35]
    v_cmp_eq_u32 vcc, s52, v13
    s_cbranch_vccnz L_oretry
L_og4:
    s_waitcnt lgkmcnt(0)
    v_mfma_f32_16x16x32_bf16 v[16:19], v[236:239], v[68:71], v[16:19]
    v_mfma_f32_16x16x32_bf16 v[20:23], v[240:243], v[68:71], v[20:23]
    v_mfma_f32_16x16x32_bf16 v[24:27], v[244:247], v[68:71], v[24:27]
    v_mfma_f32_16x16x32_bf16 v[28:31], v[248:251], v[68:71], v[28:31]
    v_mfma_f32_16x16x32_bf16 v[32:35], v[252:255], v[68:71], v[32:35]
    v_mfma_f32_16x16x32_bf16 v[16:19], v[76:79], v[72:75], v[16:19]
    v_mfma_f32_16x16x32_bf16 v[20:23], v[80:83], v[72:75], v[20:23]
    v_mfma_f32_16x16x32_bf16 v[24:27], v[84:87], v[72:75], v[24:27]
    v_mfma_f32_16x16x32_bf16 v[28:31], v[88:91], v[72:75], v[28:31]
    v_mfma_f32_16x16x32_bf16 v[32:35], v[92:95], v[72:75], v[32:35]
    s_nop 3
    ds_write_b128 v5, v[16:19] offset:0
    ds_write_b128 v5, v[20:23] offset:1024
    ds_write_b128 v5, v[24:27] offset:2048
    ds_write_b128 v5, v[28:31] offset:3072
    ds_write_b128 v5, v[32:35] offset:4096
    s_waitcnt lgkmcnt(0)
    s_barrier
    s_branch L_fin
L_c2:
L_c2h:
    v_mov_b64 v[16:17], 0
    v_mov_b64 v[18:19], 0
    v_mov_b64 v[20:21], 0
    v_mov_b64 v[22:23], 0
    v_mov_b64 v[24:25], 0
    v_mov_b64 v[26:27], 0
    v_mov_b64 v[28:29], 0
    v_mov_b64 v[30:31], 0
    v_mov_b64 v[32:33], 0
    v_mov_b64 v[34:35], 0
    s_mov_b32 s63, 5
    s_cmp_eq_u32 s4, 7
    s_cbranch_scc1 L_c7
    ds_read_b64_tr_b16 v[76:77], v6 offset:0
    ds_read_b64_tr_b16 v[78:79], v6 offset:1280
    ds_read_b64_tr_b16 v[80:81], v6 offset:32
    ds_read_b64_tr_b16 v[82:83], v6 offset:1312
    ds_read_b64_tr_b16 v[84:85], v6 offset:64
    ds_read_b64_tr_b16 v[86:87], v6 offset:1344
    ds_read_b64_tr_b16 v[88:89], v6 offset:96
    ds_read_b64_tr_b16 v[90:91], v6 offset:1376
    ds_read_b64_tr_b16 v[92:93], v6 offset:128
    ds_read_b64_tr_b16 v[94:95], v6 offset:1408
    ds_read_b64_tr_b16 v[96:97], v6 offset:6400
    ds_read_b64_tr_b16 v[98:99], v6 offset:7680
    ds_read_b64_tr_b16 v[100:101], v6 offset:6432
    ds_read_b64_tr_b16 v[102:103], v6 offset:7712
    ds_read_b64_tr_b16 v[104:105], v6 offset:6464
    ds_read_b64_tr_b16 v[106:107], v6 offset:7744
    ds_read_b64_tr_b16 v[108:109], v6 offset:6496
    ds_read_b64_tr_b16 v[110:111], v6 offset:7776
    ds_read_b64_tr_b16 v[112:113], v6 offset:6528
    ds_read_b64_tr_b16 v[114:115], v6 offset:7808
    ds_read_b64_tr_b16 v[116:117], v6 offset:12800
    ds_read_b64_tr_b16 v[118:119], v6 offset:14080
    ds_read_b64_tr_b16 v[120:121], v6 offset:12832
    ds_read_b64_tr_b16 v[122:123], v6 offset:14112
    ds_read_b64_tr_b16 v[124:125], v6 offset:12864
    ds_read_b64_tr_b16 v[126:127], v6 offset:14144
    ds_read_b64_tr_b16 v[128:129], v6 offset:12896
    ds_read_b64_tr_b16 v[130:131], v6 offset:14176
    ds_read_b64_tr_b16 v[132:133], v6 offset:12928
    ds_read_b64_tr_b16 v[134:135], v6 offset:14208
    ds_read_b64_tr_b16 v[136:137], v6 offset:19200
    ds_read_b64_tr_b16 v[138:139], v6 offset:20480
    ds_read_b64_tr_b16 v[140:141], v6 offset:19232
    ds_read_b64_tr_b16 v[142:143], v6 offset:20512
    ds_read_b64_tr_b16 v[144:145], v6 offset:19264
    ds_read_b64_tr_b16 v[146:147], v6 offset:20544
    ds_read_b64_tr_b16 v[148:149], v6 offset:19296
    ds_read_b64_tr_b16 v[150:151], v6 offset:20576
    ds_read_b64_tr_b16 v[152:153], v6 offset:19328
    ds_read_b64_tr_b16 v[154:155], v6 offset:20608
    ds_read_b64_tr_b16 v[236:237], v2 offset:2560
    ds_read_b64_tr_b16 v[238:239], v2 offset:15360
    ds_read_b64_tr_b16 v[240:241], v2 offset:2592
    ds_read_b64_tr_b16 v[242:243], v2 offset:15392
    ds_read_b64_tr_b16 v[244:245], v2 offset:2624
    ds_read_b64_tr_b16 v[246:247], v2 offset:15424
    ds_read_b64_tr_b16 v[248:249], v2 offset:2656
    ds_read_b64_tr_b16 v[250:251], v2 offset:15456
    ds_read_b64_tr_b16 v[252:253], v2 offset:2688
    ds_read_b64_tr_b16 v[254:255], v2 offset:15488
L_c4:
    s_barrier
    buffer_load_dwordx4 v[36:39], v7, s[16:19], s45 offen offset:0 sc1
    buffer_load_dwordx4 v[40:43], v7, s[16:19], s45 offen offset:1024 sc1
    buffer_load_dwordx4 v[44:47], v7, s[16:19], s45 offen offset:2048 sc1
    buffer_load_dwordx4 v[48:51], v7, s[16:19], s45 offen offset:3072 sc1
    ds_read_b64_tr_b16 v[156:157], v6 offset:25600
    ds_read_b64_tr_b16 v[158:159], v6 offset:26880
    ds_read_b64_tr_b16 v[160:161], v6 offset:25632
    ds_read_b64_tr_b16 v[162:163], v6 offset:26912
    ds_read_b64_tr_b16 v[164:165], v6 offset:25664
    ds_read_b64_tr_b16 v[166:167], v6 offset:26944
    ds_read_b64_tr_b16 v[168:169], v6 offset:25696
    ds_read_b64_tr_b16 v[170:171], v6 offset:26976
    ds_read_b64_tr_b16 v[172:173], v6 offset:25728
    ds_read_b64_tr_b16 v[174:175], v6 offset:27008
    ds_read_b64_tr_b16 v[176:177], v6 offset:32000
    ds_read_b64_tr_b16 v[178:179], v6 offset:33280
    ds_read_b64_tr_b16 v[180:181], v6 offset:32032
    ds_read_b64_tr_b16 v[182:183], v6 offset:33312
    ds_read_b64_tr_b16 v[184:185], v6 offset:32064
    ds_read_b64_tr_b16 v[186:187], v6 offset:33344
    ds_read_b64_tr_b16 v[188:189], v6 offset:32096
    ds_read_b64_tr_b16 v[190:191], v6 offset:33376
    ds_read_b64_tr_b16 v[192:193], v6 offset:32128
    ds_read_b64_tr_b16 v[194:195], v6 offset:33408
    ds_read_b64_tr_b16 v[196:197], v6 offset:38400
    ds_read_b64_tr_b16 v[198:199], v6 offset:39680
    ds_read_b64_tr_b16 v[200:201], v6 offset:38432
    ds_read_b64_tr_b16 v[202:203], v6 offset:39712
    ds_read_b64_tr_b16 v[204:205], v6 offset:38464
    ds_read_b64_tr_b16 v[206:207], v6 offset:39744
    ds_read_b64_tr_b16 v[208:209], v6 offset:38496
    ds_read_b64_tr_b16 v[210:211], v6 offset:39776
    ds_read_b64_tr_b16 v[212:213], v6 offset:38528
    ds_read_b64_tr_b16 v[214:215], v6 offset:39808
    ds_read_b64_tr_b16 v[216:217], v6 offset:44800
    ds_read_b64_tr_b16 v[218:219], v6 offset:46080
    ds_read_b64_tr_b16 v[220:221], v6 offset:44832
    ds_read_b64_tr_b16 v[222:223], v6 offset:46112
    ds_read_b64_tr_b16 v[224:225], v6 offset:44864
    ds_read_b64_tr_b16 v[226:227], v6 offset:46144
    ds_read_b64_tr_b16 v[228:229], v6 offset:44896
    ds_read_b64_tr_b16 v[230:231], v6 offset:46176
    ds_read_b64_tr_b16 v[232:233], v6 offset:44928
    ds_read_b64_tr_b16 v[234:235], v6 offset:46208
    s_waitcnt lgkmcnt(10)
    s_waitcnt vmcnt(2)
    v_max3_u32 v13, v36, v37, v38
    v_max3_u32 v12, v39, v40, v41
    v_max3_u32 v13, v13, v42, v43
    v_max_u32 v13, v13, v12
    v_cmp_eq_u32 vcc, s52, v13
    s_cbranch_vccnz L_oretry
L_og5:
    v_mfma_f32_16x16x32_bf16 v[16:19], v[76:79], v[36:39], v[16:19]
    buffer_load_dwordx4 v[52:55], v7, s[16:19], s46 offen offset:0 sc1
    v_mfma_f32_16x16x32_bf16 v[20:23], v[80:83], v[36:39], v[20:23]
    buffer_load_dwordx4 v[56:59], v7, s[16:19], s46 offen offset:1024 sc1
    v_mfma_f32_16x16x32_bf16 v[24:27], v[84:87], v[36:39], v[24:27]
    v_mfma_f32_16x16x32_bf16 v[28:31], v[88:91], v[36:39], v[28:31]
    v_mfma_f32_16x16x32_bf16 v[32:35], v[92:95], v[36:39], v[32:35]
    s_mov_b32 s63, 6
    v_mfma_f32_16x16x32_bf16 v[16:19], v[96:99], v[40:43], v[16:19]
    s_waitcnt vmcnt(2)
    v_max3_u32 v13, v44, v45, v46
    v_mfma_f32_16x16x32_bf16 v[20:23], v[100:103], v[40:43], v[20:23]
    v_max3_u32 v12, v47, v48, v49
    v_mfma_f32_16x16x32_bf16 v[24:27], v[104:107], v[40:43], v[24:27]
    v_max3_u32 v13, v13, v50, v51
    v_mfma_f32_16x16x32_bf16 v[28:31], v[108:111], v[40:43], v[28:31]
    v_max_u32 v13, v13, v12
    v_mfma_f32_16x16x32_bf16 v[32:35], v[112:115], v[40:43], v[32:35]
    v_cmp_eq_u32 vcc, s52, v13
    s_cbranch_vccnz L_oretry
L_og6:
    s_waitcnt lgkmcnt(0)
    v_mfma_f32_16x16x32_bf16 v[16:19], v[116:119], v[44:47], v[16:19]
    buffer_load_dwordx4 v[60:63], v7, s[16:19], s46 offen offset:2048 sc1
    ds_read_b64_tr_b16 v[76:77], v2 offset:28160
    v_mfma_f32_16x16x32_bf16 v[20:23], v[120:123], v[44:47], v[20:23]
    buffer_load_dwordx4 v[64:67], v7, s[16:19], s46 offen offset:3072 sc1
    ds_read_b64_tr_b16 v[78:79], v2 offset:40960
    v_mfma_f32_16x16x32_bf16 v[24:27], v[124:127], v[44:47], v[24:27]
    ds_read_b64_tr_b16 v[80:81], v2 offset:28192
    v_mfma_f32_16x16x32_bf16 v[28:31], v[128:131], v[44:47], v[28:31]
    ds_read_b64_tr_b16 v[82:83], v2 offset:40992
    v_mfma_f32_16x16x32_bf16 v[32:35], v[132:135], v[44:47], v[32:35]
    ds_read_b64_tr_b16 v[84:85], v2 offset:28224
    s_mov_b32 s63, 7
    v_mfma_f32_16x16x32_bf16 v[16:19], v[136:139], v[48:51], v[16:19]
    s_waitcnt vmcnt(2)
    v_max3_u32 v13, v52, v53, v54
    v_mfma_f32_16x16x32_bf16 v[20:23], v[140:143], v[48:51], v[20:23]
    v_max3_u32 v12, v55, v56, v57
    v_mfma_f32_16x16x32_bf16 v[24:27], v[144:147], v[48:51], v[24:27]
    v_max3_u32 v13, v13, v58, v59
    v_mfma_f32_16x16x32_bf16 v[28:31], v[148:151], v[48:51], v[28:31]
    v_max_u32 v13, v13, v12
    v_mfma_f32_16x16x32_bf16 v[32:35], v[152:155], v[48:51], v[32:35]
    v_cmp_eq_u32 vcc, s52, v13
    s_cbranch_vccnz L_oretry
L_og7:
    v_mfma_f32_16x16x32_bf16 v[16:19], v[156:159], v[52:55], v[16:19]
    buffer_load_dwordx2 v[68:69], v1, s[16:19], s47 offen offset:0 sc1
    ds_read_b64_tr_b16 v[86:87], v2 offset:41024
    v_mfma_f32_16x16x32_bf16 v[20:23], v[160:163], v[52:55], v[20:23]
    buffer_load_dwordx2 v[70:71], v1, s[16:19], s47 offen offset:512 sc1
    ds_read_b64_tr_b16 v[88:89], v2 offset:28256
    v_mfma_f32_16x16x32_bf16 v[24:27], v[164:167], v[52:55], v[24:27]
    buffer_load_dwordx2 v[72:73], v1, s[16:19], s47 offen offset:1024 sc1
    ds_read_b64_tr_b16 v[90:91], v2 offset:41056
    v_mfma_f32_16x16x32_bf16 v[28:31], v[168:171], v[52:55], v[28:31]
    buffer_load_dwordx2 v[74:75], v1, s[16:19], s47 offen offset:1536 sc1
    ds_read_b64_tr_b16 v[92:93], v2 offset:28288
    v_mfma_f32_16x16x32_bf16 v[32:35], v[172:175], v[52:55], v[32:35]
    ds_read_b64_tr_b16 v[94:95], v2 offset:41088
    s_mov_b32 s63, 8
    v_mfma_f32_16x16x32_bf16 v[16:19], v[176:179], v[56:59], v[16:19]
    s_waitcnt vmcnt(4)
    v_max3_u32 v13, v60, v61, v62
    v_mfma_f32_16x16x32_bf16 v[20:23], v[180:183], v[56:59], v[20:23]
    v_max3_u32 v12, v63, v64, v65
    v_mfma_f32_16x16x32_bf16 v[24:27], v[184:187], v[56:59], v[24:27]
    v_max3_u32 v13, v13, v66, v67
    v_mfma_f32_16x16x32_bf16 v[28:31], v[188:191], v[56:59], v[28:31]
    v_max_u32 v13, v13, v12
    v_mfma_f32_16x16x32_bf16 v[32:35], v[192:195], v[56:59], v[32:35]
    v_cmp_eq_u32 vcc, s52, v13
    s_cbranch_vccnz L_oretry
L_og8:
    v_mfma_f32_16x16x32_bf16 v[16:19], v[196:199], v[60:63], v[16:19]
    v_mfma_f32_16x16x32_bf16 v[20:23], v[200:203], v[60:63], v[20:23]
    v_mfma_f32_16x16x32_bf16 v[24:27], v[204:207], v[60:63], v[24:27]
    v_mfma_f32_16x16x32_bf16 v[28:31], v[208:211], v[60:63], v[28:31]
    v_mfma_f32_16x16x32_bf16 v[32:35], v[212:215], v[60:63], v[32:35]
    s_mov_b32 s63, 9
    v_mfma_f32_16x16x32_bf16 v[16:19], v[216:219], v[64:67], v[16:19]
    s_waitcnt vmcnt(0)
    v_max3_u32 v13, v68, v69, v70
    v_mfma_f32_16x16x32_bf16 v[20:23], v[220:223], v[64:67], v[20:23]
    v_max3_u32 v12, v71, v72, v73
    v_mfma_f32_16x16x32_bf16 v[24:27], v[224:227], v[64:67], v[24:27]
    v_max3_u32 v13, v13, v74, v75
    v_mfma_f32_16x16x32_bf16 v[28:31], v[228:231], v[64:67], v[28:31]
    v_max_u32 v13, v13, v12
    v_mfma_f32_16x16x32_bf16 v[32:35], v[232:235], v[64:67], v[32:35]
    v_cmp_eq_u32 vcc, s52, v13
    s_cbranch_vccnz L_oretry
L_og9:
    s_waitcnt lgkmcnt(0)
    s_barrier
    ds_read_b128 v[36:39], v5 offset:0
    ds_read_b128 v[40:43], v5 offset:1024
    ds_read_b128 v[44:47], v5 offset:2048
    ds_read_b128 v[48:51], v5 offset:3072
    ds_read_b128 v[52:55], v5 offset:4096
    v_mfma_f32_16x16x32_bf16 v[16:19], v[236:239], v[68:71], v[16:19]
    v_mfma_f32_16x16x32_bf16 v[20:23], v[240:243], v[68:71], v[20:23]
    v_mfma_f32_16x16x32_bf16 v[24:27], v[244:247], v[68:71], v[24:27]
    v_mfma_f32_16x16x32_bf16 v[28:31], v[248:251], v[68:71], v[28:31]
    v_mfma_f32_16x16x32_bf16 v[32:35], v[252:255], v[68:71], v[32:35]
    v_mfma_f32_16x16x32_bf16 v[16:19], v[76:79], v[72:75], v[16:19]
    v_mfma_f32_16x16x32_bf16 v[20:23], v[80:83], v[72:75], v[20:23]
    v_mfma_f32_16x16x32_bf16 v[24:27], v[84:87], v[72:75], v[24:27]
    v_mfma_f32_16x16x32_bf16 v[28:31], v[88:91], v[72:75], v[28:31]
    v_mfma_f32_16x16x32_bf16 v[32:35], v[92:95], v[72:75], v[32:35]
    s_waitcnt lgkmcnt(0)
    s_nop 2
    v_add_f32 v16, v16, v36
    v_add_f32 v17, v17, v37
    v_add_f32 v18, v18, v38
    v_add_f32 v19, v19, v39
    v_cvt_pk_bf16_f32 v16, v16, v17
    v_cvt_pk_bf16_f32 v17, v18, v19
    ds_write_b64 v3, v[16:17] offset:0
    v_pk_add_f32 v[20:21], v[20:21], v[40:41]
    v_pk_add_f32 v[22:23], v[22:23], v[42:43]
    v_cvt_pk_bf16_f32 v20, v20, v21
    v_cvt_pk_bf16_f32 v21, v22, v23
    ds_write_b64 v3, v[20:21] offset:32
    v_pk_add_f32 v[24:25], v[24:25], v[44:45]
    v_pk_add_f32 v[26:27], v[26:27], v[46:47]
    v_cvt_pk_bf16_f32 v24, v24, v25
    v_cvt_pk_bf16_f32 v25, v26, v27
    ds_write_b64 v3, v[24:25] offset:64
    v_pk_add_f32 v[28:29], v[28:29], v[48:49]
    v_pk_add_f32 v[30:31], v[30:31], v[50:51]
    v_cvt_pk_bf16_f32 v28, v28, v29
    v_cvt_pk_bf16_f32 v29, v30, v31
    ds_write_b64 v3, v[28:29] offset:96
    v_pk_add_f32 v[32:33], v[32:33], v[52:53]
    v_pk_add_f32 v[34:35], v[34:35], v[54:55]
    v_cvt_pk_bf16_f32 v32, v32, v33
    v_cvt_pk_bf16_f32 v33, v34, v35
    ds_write_b64 v3, v[32:33] offset:128
    ds_read_b128 v[36:39], v11 offset:0
    ds_read_b128 v[40:43], v11 offset:1024
    ds_read_b128 v[44:47], v11 offset:2048
    s_waitcnt lgkmcnt(2)
    buffer_store_dwordx4 v[36:39], v8, s[24:27], s48 offen offset:0
    s_waitcnt lgkmcnt(1)
    buffer_store_dwordx4 v[40:43], v9, s[24:27], s48 offen offset:1024
    s_waitcnt lgkmcnt(0)
    buffer_store_dwordx4 v[44:47], v10, s[24:27], s48 offen offset:2048
L_fin:
    s_endpgm
L_oretry:
    s_mov_b32 s3, 0
L_poll_25:
    s_add_u32 s3, s3, 1
    s_cmp_gt_u32 s3, 200000
    s_cbranch_scc1 L_pdone_27
    buffer_load_dwordx4 v[36:39], v7, s[16:19], s45 offen offset:0 sc1
    buffer_load_dwordx4 v[40:43], v7, s[16:19], s45 offen offset:1024 sc1
    buffer_load_dwordx4 v[44:47], v7, s[16:19], s45 offen offset:2048 sc1
    buffer_load_dwordx4 v[48:51], v7, s[16:19], s45 offen offset:3072 sc1
    buffer_load_dwordx4 v[52:55], v7, s[16:19], s46 offen offset:0 sc1
    buffer_load_dwordx4 v[56:59], v7, s[16:19], s46 offen offset:1024 sc1
    buffer_load_dwordx4 v[60:63], v7, s[16:19], s46 offen offset:2048 sc1
    buffer_load_dwordx4 v[64:67], v7, s[16:19], s46 offen offset:3072 sc1
    buffer_load_dwordx2 v[68:69], v1, s[16:19], s47 offen offset:0 sc1
    buffer_load_dwordx2 v[70:71], v1, s[16:19], s47 offen offset:512 sc1
    buffer_load_dwordx2 v[72:73], v1, s[16:19], s47 offen offset:1024 sc1
    buffer_load_dwordx2 v[74:75], v1, s[16:19], s47 offen offset:1536 sc1
L_chk_26:
    s_waitcnt vmcnt(0)
    v_max3_u32 v13, v36, v37, v38
    v_max3_u32 v13, v13, v39, v40
    v_max3_u32 v13, v13, v41, v42
    v_max3_u32 v13, v13, v43, v44
    v_max3_u32 v13, v13, v45, v46
    v_max3_u32 v13, v13, v47, v48
    v_max3_u32 v13, v13, v49, v50
    v_max3_u32 v13, v13, v51, v52
    v_max3_u32 v13, v13, v53, v54
    v_max3_u32 v13, v13, v55, v56
    v_max3_u32 v13, v13, v57, v58
    v_max3_u32 v13, v13, v59, v60
    v_max3_u32 v13, v13, v61, v62
    v_max3_u32 v13, v13, v63, v64
    v_max3_u32 v13, v13, v65, v66
    v_max3_u32 v13, v13, v67, v68
    v_max3_u32 v13, v13, v69, v70
    v_max3_u32 v13, v13, v71, v72
    v_max3_u32 v13, v13, v73, v74
    v_max_u32 v13, v13, v75
    v_cmp_eq_u32 vcc, s52, v13
    s_cbranch_vccnz L_poll_25
L_pdone_27:
    s_cmp_gt_u32 s3, 200000
    s_cselect_b32 s52, 1, s52
    s_cmp_eq_u32 s63, 0
    s_cbranch_scc1 L_og0
    s_cmp_eq_u32 s63, 1
    s_cbranch_scc1 L_og1
    s_cmp_eq_u32 s63, 2
    s_cbranch_scc1 L_og2
    s_cmp_eq_u32 s63, 3
    s_cbranch_scc1 L_og3
    s_cmp_eq_u32 s63, 4
    s_cbranch_scc1 L_og4
    s_cmp_eq_u32 s63, 5
    s_cbranch_scc1 L_og5
    s_cmp_eq_u32 s63, 6
    s_cbranch_scc1 L_og6
    s_cmp_eq_u32 s63, 7
    s_cbranch_scc1 L_og7
    s_cmp_eq_u32 s63, 8
    s_cbranch_scc1 L_og8
    s_branch L_og9
L_y0:
    s_cmp_eq_u32 s61, 2
    s_cselect_b32 s60, 20480, 0
    s_cselect_b32 s100, s101, s100
    s_and_b32 s3, s6, 7
    s_mul_i32 s3, s3, 2560
    s_add_u32 s60, s60, s3
    s_add_u32 s60, s60, 2883584
    v_and_b32 v15, 7, v0
    v_lshlrev_b32 v15, 4, v15
    v_and_b32 v13, 48, v0
    v_lshl_add_u32 v15, v13, 3, v15
    buffer_load_dwordx4 v[56:59], v15, s[16:19], s60 offen offset:0 sc1
    buffer_load_dwordx4 v[60:63], v15, s[16:19], s60 offen offset:512 sc1
    buffer_load_dwordx4 v[64:67], v15, s[16:19], s60 offen offset:1024 sc1
    buffer_load_dwordx4 v[68:71], v15, s[16:19], s60 offen offset:1536 sc1
    buffer_load_dwordx4 v[72:75], v15, s[16:19], s60 offen offset:2048 sc1
    s_branch L_y1
L_y4:
    s_and_b32 s53, s100, 0xffff0000
    s_cmp_lt_i32 s53, 0
    s_mov_b32 s3, 0xffff0000
    s_cselect_b32 s3, 0x80000000, s3
    s_xor_b32 s53, s53, s3
    v_mov_b32 v10, 0xbfb8aa3b
    v_mul_f32 v10, s53, v10
    v_exp_f32 v10, v10
    s_nop 0
    v_add_f32 v10, 1.0, v10
    v_rcp_f32 v10, v10
    s_andn2_b32 s3, 15, s100
    v_and_b32 v13, 15, v0
    v_cmp_eq_u32 s[58:59], s3, v13
    v_cvt_pk_bf16_f32 v10, v10, v10
    v_and_b32 v10, 0xffff0000, v10
    s_waitcnt vmcnt(0)
    v_max3_u32 v13, v56, v57, v58
    v_max3_u32 v13, v13, v59, v60
    v_max3_u32 v13, v13, v61, v62
    v_max3_u32 v13, v13, v63, v64
    v_max3_u32 v13, v13, v65, v66
    v_max3_u32 v13, v13, v67, v68
    v_max3_u32 v13, v13, v69, v70
    v_max3_u32 v13, v13, v71, v72
    v_max3_u32 v13, v13, v73, v74
    v_max_u32 v13, v13, v75
    v_cmp_eq_u32 vcc, s52, v13
    s_cbranch_vccz L_ok_28
    s_mov_b32 s3, 0
L_poll_29:
    s_add_u32 s3, s3, 1
    s_cmp_gt_u32 s3, 200000
    s_cbranch_scc1 L_pdone_31
    buffer_load_dwordx4 v[56:59], v15, s[16:19], s60 offen offset:0 sc1
    buffer_load_dwordx4 v[60:63], v15, s[16:19], s60 offen offset:512 sc1
    buffer_load_dwordx4 v[64:67], v15, s[16:19], s60 offen offset:1024 sc1
    buffer_load_dwordx4 v[68:71], v15, s[16:19], s60 offen offset:1536 sc1
    buffer_load_dwordx4 v[72:75], v15, s[16:19], s60 offen offset:2048 sc1
L_chk_30:
    s_waitcnt vmcnt(0)
    v_max3_u32 v13, v56, v57, v58
    v_max3_u32 v13, v13, v59, v60
    v_max3_u32 v13, v13, v61, v62
    v_max3_u32 v13, v13, v63, v64
    v_max3_u32 v13, v13, v65, v66
    v_max3_u32 v13, v13, v67, v68
    v_max3_u32 v13, v13, v69, v70
    v_max3_u32 v13, v13, v71, v72
    v_max3_u32 v13, v13, v73, v74
    v_max_u32 v13, v13, v75
    v_cmp_eq_u32 vcc, s52, v13
    s_cbranch_vccnz L_poll_29
L_pdone_31:
L_ok_28:
    v_add_f32_dpp v56, v56, v56 quad_perm:[1,0,3,2] row_mask:0xf bank_mask:0xf
    v_add_f32_dpp v57, v57, v57 quad_perm:[1,0,3,2] row_mask:0xf bank_mask:0xf
    v_add_f32_dpp v58, v58, v58 quad_perm:[1,0,3,2] row_mask:0xf bank_mask:0xf
    v_add_f32_dpp v59, v59, v59 quad_perm:[1,0,3,2] row_mask:0xf bank_mask:0xf
    v_add_f32_dpp v60, v60, v60 quad_perm:[1,0,3,2] row_mask:0xf bank_mask:0xf
    v_add_f32_dpp v61, v61, v61 quad_perm:[1,0,3,2] row_mask:0xf bank_mask:0xf
    v_add_f32_dpp v62, v62, v62 quad_perm:[1,0,3,2] row_mask:0xf bank_mask:0xf
    v_add_f32_dpp v63, v63, v63 quad_perm:[1,0,3,2] row_mask:0xf bank_mask:0xf
    v_add_f32_dpp v64, v64, v64 quad_perm:[1,0,3,2] row_mask:0xf bank_mask:0xf
    v_add_f32_dpp v65, v65, v65 quad_perm:[1,0,3,2] row_mask:0xf bank_mask:0xf
    v_add_f32_dpp v66, v66, v66 quad_perm:[1,0,3,2] row_mask:0xf bank_mask:0xf
    v_add_f32_dpp v67, v67, v67 quad_perm:[1,0,3,2] row_mask:0xf bank_mask:0xf
    v_add_f32_dpp v68, v68, v68 quad_perm:[1,0,3,2] row_mask:0xf bank_mask:0xf
    v_add_f32_dpp v69, v69, v69 quad_perm:[1,0,3,2] row_mask:0xf bank_mask:0xf
    v_add_f32_dpp v70, v70, v70 quad_perm:[1,0,3,2] row_mask:0xf bank_mask:0xf
    v_add_f32_dpp v71, v71, v71 quad_perm:[1,0,3,2] row_mask:0xf bank_mask:0xf
    v_add_f32_dpp v72, v72, v72 quad_perm:[1,0,3,2] row_mask:0xf bank_mask:0xf
    v_add_f32_dpp v73, v73, v73 quad_perm:[1,0,3,2] row_mask:0xf bank_mask:0xf
    v_add_f32_dpp v74, v74, v74 quad_perm:[1,0,3,2] row_mask:0xf bank_mask:0xf
    v_add_f32_dpp v75, v75, v75 quad_perm:[1,0,3,2] row_mask:0xf bank_mask:0xf
    v_add_f32_dpp v56, v56, v56 quad_perm:[2,3,0,1] row_mask:0xf bank_mask:0xf
    v_add_f32_dpp v57, v57, v57 quad_perm:[2,3,0,1] row_mask:0xf bank_mask:0xf
    v_add_f32_dpp v58, v58, v58 quad_perm:[2,3,0,1] row_mask:0xf bank_mask:0xf
    v_add_f32_dpp v59, v59, v59 quad_perm:[2,3,0,1] row_mask:0xf bank_mask:0xf
    v_add_f32_dpp v60, v60, v60 quad_perm:[2,3,0,1] row_mask:0xf bank_mask:0xf
    v_add_f32_dpp v61, v61, v61 quad_perm:[2,3,0,1] row_mask:0xf bank_mask:0xf
    v_add_f32_dpp v62, v62, v62 quad_perm:[2,3,0,1] row_mask:0xf bank_mask:0xf
    v_add_f32_dpp v63, v63, v63 quad_perm:[2,3,0,1] row_mask:0xf bank_mask:0xf
    v_add_f32_dpp v64, v64, v64 quad_perm:[2,3,0,1] row_mask:0xf bank_mask:0xf
    v_add_f32_dpp v65, v65, v65 quad_perm:[2,3,0,1] row_mask:0xf bank_mask:0xf
    v_add_f32_dpp v66, v66, v66 quad_perm:[2,3,0,1] row_mask:0xf bank_mask:0xf
    v_add_f32_dpp v67, v67, v67 quad_perm:[2,3,0,1] row_mask:0xf bank_mask:0xf
    v_add_f32_dpp v68, v68, v68 quad_perm:[2,3,0,1] row_mask:0xf bank_mask:0xf
    v_add_f32_dpp v69, v69, v69 quad_perm:[2,3,0,1] row_mask:0xf bank_mask:0xf
    v_add_f32_dpp v70, v70, v70 quad_perm:[2,3,0,1] row_mask:0xf bank_mask:0xf
    v_add_f32_dpp v71, v71, v71 quad_perm:[2,3,0,1] row_mask:0xf bank_mask:0xf
    v_add_f32_dpp v72, v72, v72 quad_perm:[2,3,0,1] row_mask:0xf bank_mask:0xf
    v_add_f32_dpp v73, v73, v73 quad_perm:[2,3,0,1] row_mask:0xf bank_mask:0xf
    v_add_f32_dpp v74, v74, v74 quad_perm:[2,3,0,1] row_mask:0xf bank_mask:0xf
    v_add_f32_dpp v75, v75, v75 quad_perm:[2,3,0,1] row_mask:0xf bank_mask:0xf
    s_branch L_y5
L_y6:
    s_mov_b32 s3, 0
L_poll_32:
    s_add_u32 s3, s3, 1
    s_cmp_gt_u32 s3, 200000
    s_cbranch_scc1 L_pdone_34
    buffer_load_dwordx4 v[56:59], v15, s[16:19], s60 offen offset:0 sc1
    buffer_load_dwordx4 v[60:63], v15, s[16:19], s60 offen offset:512 sc1
    buffer_load_dwordx4 v[64:67], v15, s[16:19], s60 offen offset:1024 sc1
    buffer_load_dwordx4 v[68:71], v15, s[16:19], s60 offen offset:1536 sc1
    buffer_load_dwordx4 v[72:75], v15, s[16:19], s60 offen offset:2048 sc1
L_chk_33:
    s_waitcnt vmcnt(0)
    v_max3_u32 v13, v56, v57, v58
    v_max3_u32 v13, v13, v59, v60
    v_max3_u32 v13, v13, v61, v62
    v_max3_u32 v13, v13, v63, v64
    v_max3_u32 v13, v13, v65, v66
    v_max3_u32 v13, v13, v67, v68
    v_max3_u32 v13, v13, v69, v70
    v_max3_u32 v13, v13, v71, v72
    v_max3_u32 v13, v13, v73, v74
    v_max_u32 v13, v13, v75
    v_cmp_eq_u32 vcc, s52, v13
    s_cbranch_vccnz L_poll_32
L_pdone_34:
    s_and_b32 s53, s100, 0xffff0000
    s_cmp_lt_i32 s53, 0
    s_mov_b32 s3, 0xffff0000
    s_cselect_b32 s3, 0x80000000, s3
    s_xor_b32 s53, s53, s3
    v_mov_b32 v10, 0xbfb8aa3b
    v_mul_f32 v10, s53, v10
    v_exp_f32 v10, v10
    s_nop 0
    v_add_f32 v10, 1.0, v10
    v_rcp_f32 v10, v10
    s_andn2_b32 s3, 15, s100
    v_and_b32 v13, 15, v0
    v_cmp_eq_u32 s[58:59], s3, v13
    v_cvt_pk_bf16_f32 v10, v10, v10
    v_and_b32 v10, 0xffff0000, v10
    v_add_f32_dpp v56, v56, v56 quad_perm:[1,0,3,2] row_mask:0xf bank_mask:0xf
    v_add_f32_dpp v57, v57, v57 quad_perm:[1,0,3,2] row_mask:0xf bank_mask:0xf
    v_add_f32_dpp v58, v58, v58 quad_perm:[1,0,3,2] row_mask:0xf bank_mask:0xf
    v_add_f32_dpp v59, v59, v59 quad_perm:[1,0,3,2] row_mask:0xf bank_mask:0xf
    v_add_f32_dpp v60, v60, v60 quad_perm:[1,0,3,2] row_mask:0xf bank_mask:0xf
    v_add_f32_dpp v61, v61, v61 quad_perm:[1,0,3,2] row_mask:0xf bank_mask:0xf
    v_add_f32_dpp v62, v62, v62 quad_perm:[1,0,3,2] row_mask:0xf bank_mask:0xf
    v_add_f32_dpp v63, v63, v63 quad_perm:[1,0,3,2] row_mask:0xf bank_mask:0xf
    v_add_f32_dpp v64, v64, v64 quad_perm:[1,0,3,2] row_mask:0xf bank_mask:0xf
    v_add_f32_dpp v65, v65, v65 quad_perm:[1,0,3,2] row_mask:0xf bank_mask:0xf
    v_add_f32_dpp v66, v66, v66 quad_perm:[1,0,3,2] row_mask:0xf bank_mask:0xf
    v_add_f32_dpp v67, v67, v67 quad_perm:[1,0,3,2] row_mask:0xf bank_mask:0xf
    v_add_f32_dpp v68, v68, v68 quad_perm:[1,0,3,2] row_mask:0xf bank_mask:0xf
    v_add_f32_dpp v69, v69, v69 quad_perm:[1,0,3,2] row_mask:0xf bank_mask:0xf
    v_add_f32_dpp v70, v70, v70 quad_perm:[1,0,3,2] row_mask:0xf bank_mask:0xf
    v_add_f32_dpp v71, v71, v71 quad_perm:[1,0,3,2] row_mask:0xf bank_mask:0xf
    v_add_f32_dpp v72, v72, v72 quad_perm:[1,0,3,2] row_mask:0xf bank_mask:0xf
    v_add_f32_dpp v73, v73, v73 quad_perm:[1,0,3,2] row_mask:0xf bank_mask:0xf
    v_add_f32_dpp v74, v74, v74 quad_perm:[1,0,3,2] row_mask:0xf bank_mask:0xf
    v_add_f32_dpp v75, v75, v75 quad_perm:[1,0,3,2] row_mask:0xf bank_mask:0xf
    v_add_f32_dpp v56, v56, v56 quad_perm:[2,3,0,1] row_mask:0xf bank_mask:0xf
    v_add_f32_dpp v57, v57, v57 quad_perm:[2,3,0,1] row_mask:0xf bank_mask:0xf
    v_add_f32_dpp v58, v58, v58 quad_perm:[2,3,0,1] row_mask:0xf bank_mask:0xf
    v_add_f32_dpp v59, v59, v59 quad_perm:[2,3,0,1] row_mask:0xf bank_mask:0xf
    v_add_f32_dpp v60, v60, v60 quad_perm:[2,3,0,1] row_mask:0xf bank_mask:0xf
    v_add_f32_dpp v61, v61, v61 quad_perm:[2,3,0,1] row_mask:0xf bank_mask:0xf
    v_add_f32_dpp v62, v62, v62 quad_perm:[2,3,0,1] row_mask:0xf bank_mask:0xf
    v_add_f32_dpp v63, v63, v63 quad_perm:[2,3,0,1] row_mask:0xf bank_mask:0xf
    v_add_f32_dpp v64, v64, v64 quad_perm:[2,3,0,1] row_mask:0xf bank_mask:0xf
    v_add_f32_dpp v65, v65, v65 quad_perm:[2,3,0,1] row_mask:0xf bank_mask:0xf
    v_add_f32_dpp v66, v66, v66 quad_perm:[2,3,0,1] row_mask:0xf bank_mask:0xf
    v_add_f32_dpp v67, v67, v67 quad_perm:[2,3,0,1] row_mask:0xf bank_mask:0xf
    v_add_f32_dpp v68, v68, v68 quad_perm:[2,3,0,1] row_mask:0xf bank_mask:0xf
    v_add_f32_dpp v69, v69, v69 quad_perm:[2,3,0,1] row_mask:0xf bank_mask:0xf
    v_add_f32_dpp v70, v70, v70 quad_perm:[2,3,0,1] row_mask:0xf bank_mask:0xf
    v_add_f32_dpp v71, v71, v71 quad_perm:[2,3,0,1] row_mask:0xf bank_mask:0xf
    v_add_f32_dpp v72, v72, v72 quad_perm:[2,3,0,1] row_mask:0xf bank_mask:0xf
    v_add_f32_dpp v73, v73, v73 quad_perm:[2,3,0,1] row_mask:0xf bank_mask:0xf
    v_add_f32_dpp v74, v74, v74 quad_perm:[2,3,0,1] row_mask:0xf bank_mask:0xf
    v_add_f32_dpp v75, v75, v75 quad_perm:[2,3,0,1] row_mask:0xf bank_mask:0xf
L_y2:
    v_add_f32_dpp v56, v56, v56 row_half_mirror row_mask:0xf bank_mask:0xf
    v_add_f32_dpp v57, v57, v57 row_half_mirror row_mask:0xf bank_mask:0xf
    v_add_f32_dpp v58, v58, v58 row_half_mirror row_mask:0xf bank_mask:0xf
    v_add_f32_dpp v59, v59, v59 row_half_mirror row_mask:0xf bank_mask:0xf
    v_add_f32_dpp v60, v60, v60 row_half_mirror row_mask:0xf bank_mask:0xf
    v_add_f32_dpp v61, v61, v61 row_half_mirror row_mask:0xf bank_mask:0xf
    v_add_f32_dpp v62, v62, v62 row_half_mirror row_mask:0xf bank_mask:0xf
    v_add_f32_dpp v63, v63, v63 row_half_mirror row_mask:0xf bank_mask:0xf
    v_add_f32_dpp v64, v64, v64 row_half_mirror row_mask:0xf bank_mask:0xf
    v_add_f32_dpp v65, v65, v65 row_half_mirror row_mask:0xf bank_mask:0xf
    v_add_f32_dpp v66, v66, v66 row_half_mirror row_mask:0xf bank_mask:0xf
    v_add_f32_dpp v67, v67, v67 row_half_mirror row_mask:0xf bank_mask:0xf
    v_add_f32_dpp v68, v68, v68 row_half_mirror row_mask:0xf bank_mask:0xf
    v_add_f32_dpp v69, v69, v69 row_half_mirror row_mask:0xf bank_mask:0xf
    v_add_f32_dpp v70, v70, v70 row_half_mirror row_mask:0xf bank_mask:0xf
    v_add_f32_dpp v71, v71, v71 row_half_mirror row_mask:0xf bank_mask:0xf
    v_add_f32_dpp v72, v72, v72 row_half_mirror row_mask:0xf bank_mask:0xf
    v_add_f32_dpp v73, v73, v73 row_half_mirror row_mask:0xf bank_mask:0xf
    v_add_f32_dpp v74, v74, v74 row_half_mirror row_mask:0xf bank_mask:0xf
    v_add_f32_dpp v75, v75, v75 row_half_mirror row_mask:0xf bank_mask:0xf
    s_mov_b64 exec, s[58:59]
    v_pk_fma_f32 v[16:17], v[56:57], v[10:11], v[16:17] op_sel_hi:[1,0,1]
    v_pk_fma_f32 v[18:19], v[58:59], v[10:11], v[18:19] op_sel_hi:[1,0,1]
    v_pk_fma_f32 v[20:21], v[60:61], v[10:11], v[20:21] op_sel_hi:[1,0,1]
    v_pk_fma_f32 v[22:23], v[62:63], v[10:11], v[22:23] op_sel_hi:[1,0,1]
    v_pk_fma_f32 v[24:25], v[64:65], v[10:11], v[24:25] op_sel_hi:[1,0,1]
    v_pk_fma_f32 v[26:27], v[66:67], v[10:11], v[26:27] op_sel_hi:[1,0,1]
    v_pk_fma_f32 v[28:29], v[68:69], v[10:11], v[28:29] op_sel_hi:[1,0,1]
    v_pk_fma_f32 v[30:31], v[70:71], v[10:11], v[30:31] op_sel_hi:[1,0,1]
    v_pk_fma_f32 v[32:33], v[72:73], v[10:11], v[32:33] op_sel_hi:[1,0,1]
    v_pk_fma_f32 v[34:35], v[74:75], v[10:11], v[34:35] op_sel_hi:[1,0,1]
    s_mov_b64 exec, -1
    s_cmp_eq_u32 s61, 3
    s_cbranch_scc0 L_y3
    s_mov_b32 s61, 2
    s_mov_b32 s100, s101
    s_add_u32 s60, s60, 20480
    s_branch L_y6
L_c7:
    v_mov_b32 v38, 0xff81ff91
    s_mov_b64 exec, 3
    v_mov_b32 v38, 0
    buffer_atomic_or v38, v4, s[16:19], s50 offen sc0 sc1
    s_mov_b64 exec, -1
    ds_read_b64_tr_b16 v[76:77], v6 offset:0
    ds_read_b64_tr_b16 v[78:79], v6 offset:1280
    ds_read_b64_tr_b16 v[80:81], v6 offset:32
    ds_read_b64_tr_b16 v[82:83], v6 offset:1312
    ds_read_b64_tr_b16 v[84:85], v6 offset:64
    ds_read_b64_tr_b16 v[86:87], v6 offset:1344
    ds_read_b64_tr_b16 v[88:89], v6 offset:96
    ds_read_b64_tr_b16 v[90:91], v6 offset:1376
    ds_read_b64_tr_b16 v[92:93], v6 offset:128
    ds_read_b64_tr_b16 v[94:95], v6 offset:1408
    ds_read_b64_tr_b16 v[96:97], v6 offset:6400
    ds_read_b64_tr_b16 v[98:99], v6 offset:7680
    ds_read_b64_tr_b16 v[100:101], v6 offset:6432
    ds_read_b64_tr_b16 v[102:103], v6 offset:7712
    ds_read_b64_tr_b16 v[104:105], v6 offset:6464
    ds_read_b64_tr_b16 v[106:107], v6 offset:7744
    ds_read_b64_tr_b16 v[108:109], v6 offset:6496
    ds_read_b64_tr_b16 v[110:111], v6 offset:7776
    ds_read_b64_tr_b16 v[112:113], v6 offset:6528
    ds_read_b64_tr_b16 v[114:115], v6 offset:7808
    ds_read_b64_tr_b16 v[116:117], v6 offset:12800
    ds_read_b64_tr_b16 v[118:119], v6 offset:14080
    ds_read_b64_tr_b16 v[120:121], v6 offset:12832
    ds_read_b64_tr_b16 v[122:123], v6 offset:14112
    ds_read_b64_tr_b16 v[124:125], v6 offset:12864
    ds_read_b64_tr_b16 v[126:127], v6 offset:14144
    ds_read_b64_tr_b16 v[128:129], v6 offset:12896
    ds_read_b64_tr_b16 v[130:131], v6 offset:14176
    ds_read_b64_tr_b16 v[132:133], v6 offset:12928
    ds_read_b64_tr_b16 v[134:135], v6 offset:14208
    ds_read_b64_tr_b16 v[136:137], v6 offset:19200
    ds_read_b64_tr_b16 v[138:139], v6 offset:20480
    ds_read_b64_tr_b16 v[140:141], v6 offset:19232
    ds_read_b64_tr_b16 v[142:143], v6 offset:20512
    ds_read_b64_tr_b16 v[144:145], v6 offset:19264
    ds_read_b64_tr_b16 v[146:147], v6 offset:20544
    ds_read_b64_tr_b16 v[148:149], v6 offset:19296
    ds_read_b64_tr_b16 v[150:151], v6 offset:20576
    ds_read_b64_tr_b16 v[152:153], v6 offset:19328
    ds_read_b64_tr_b16 v[154:155], v6 offset:20608
    ds_read_b64_tr_b16 v[236:237], v2 offset:2560
    ds_read_b64_tr_b16 v[238:239], v2 offset:15360
    ds_read_b64_tr_b16 v[240:241], v2 offset:2592
    ds_read_b64_tr_b16 v[242:243], v2 offset:15392
    ds_read_b64_tr_b16 v[244:245], v2 offset:2624
    ds_read_b64_tr_b16 v[246:247], v2 offset:15424
    ds_read_b64_tr_b16 v[248:249], v2 offset:2656
    ds_read_b64_tr_b16 v[250:251], v2 offset:15456
    ds_read_b64_tr_b16 v[252:253], v2 offset:2688
    ds_read_b64_tr_b16 v[254:255], v2 offset:15488
    s_waitcnt vmcnt(0)
    v_cmp_ne_u32 vcc, 0xff81ff91, v38
    s_cbranch_vccz L_c4
    s_mov_b64 exec, 0x3
    s_mov_b32 s3, 0
L_cp_35:
    v_mov_b32 v12, 0
    s_add_u32 s3, s3, 1
    s_cmp_gt_u32 s3, 200000
    s_cbranch_scc1 L_cdone_36
    buffer_atomic_or v12, v4, s[16:19], s50 offen sc0 sc1
    s_waitcnt vmcnt(0)
    v_cmp_ne_u32 vcc, 0xff81ff91, v12
    s_cbranch_vccnz L_cp_35
L_cdone_36:
    s_mov_b64 exec, -1
    s_branch L_c4
L_rlate:
    s_mov_b32 s3, 0
L_rp_37:
    v_cmp_eq_u32 vcc, 0, v42
    s_cbranch_vccz L_rdone_38
    s_add_u32 s3, s3, 1
    s_cmp_gt_u32 s3, 200000
    s_cbranch_scc1 L_rdone_38
    s_sleep 8
    buffer_load_dword v42, v43, s[28:31], 0 offen sc1
    s_waitcnt vmcnt(0)
    s_branch L_rp_37
L_rdone_38:
    s_branch L_rret
L_kagain:
    s_add_u32 s55, s55, 1
    s_cmp_gt_u32 s55, 200000
    s_cbranch_scc0 L_kfull
    s_branch L_kred
L_qlate:
    s_mov_b32 s3, 0
L_poll_39:
    s_add_u32 s3, s3, 1
    s_cmp_gt_u32 s3, 200000
    s_cbranch_scc1 L_pdone_41
    s_mov_b64 exec, 1
    buffer_load_dword v253, off, s[16:19], s39 sc1
    s_mov_b64 exec, -1
L_chk_40:
    s_waitcnt vmcnt(0)
    v_mov_b32 v92, v253
    v_cmp_eq_u32 vcc, s52, v92
    s_cbranch_vccnz L_poll_39
L_pdone_41:
    buffer_load_dwordx4 v[16:19], v7, s[16:19], s38 offen sc1
    buffer_load_dwordx2 v[20:21], v1, s[16:19], s38 offen offset:1024 sc1
    buffer_load_dword v94, v255, s[16:19], 0 offen sc1
    s_waitcnt vmcnt(0)
    s_branch L_phi
L_qaddr:
    s_sub_u32 s3, s57, 8
    s_mul_i32 s58, s3, 655360
    s_lshl1_add_u32 s3, s54, s61
    s_mul_i32 s3, s3, 2560
    s_add_u32 s58, s58, s3
    s_add_u32 s58, s58, 65536
    s_mul_i32 s3, s60, 163840
    s_sub_u32 s62, 491520, s3
    v_mov_b32 v12, s3
    v_mov_b32 v13, s62
    v_cmp_gt_u32 vcc, 32, v0
    s_add_u32 s59, s58, s62
    s_add_u32 s62, s58, s3
    v_and_b32 v7, 1, v3
    v_mul_u32_u24 v7, 81920, v7
    v_cndmask_b32 v12, v13, v12, vcc
    v_lshrrev_b32 v14, 5, v0
    v_lshl_add_u32 v14, v14, 9, v7
    v_lshl_add_u32 v240, v6, 4, v14
    v_add_u32 v12, v12, v7
    v_lshl_add_u32 v241, v6, 3, v12
    v_mov_b32 v242, 156928
    v_mov_b64 v[250:251], 0
    v_lshlrev_b32 v252, 10, v0
    s_lshl2_add_u32 s3, s54, s57
    s_lshl_b32 s3, s3, 7
    s_lshl4_add_u32 s3, s61, s3
    s_add_u32 s3, s3, 44032
    s_lshl2_add_u32 s56, s60, s3
    s_xor_b32 s55, s56, 12
    s_cmp_eq_u32 s7, 16
    s_cbranch_scc1 L_qaret
    s_waitcnt vmcnt(0)
    s_branch L_qaret
L_qepi:
    ds_read_b32 v243, v242
    v_mfma_f32_16x16x16_bf16 v[24:27], v[228:229], v[208:209], v[24:27]
    v_mfma_f32_16x16x16_bf16 v[28:31], v[230:231], v[208:209], v[28:31]
    v_mfma_f32_16x16x16_bf16 v[32:35], v[232:233], v[208:209], v[32:35]
    v_mfma_f32_16x16x16_bf16 v[44:47], v[228:229], v[212:213], v[44:47]
    v_mfma_f32_16x16x16_bf16 v[48:51], v[230:231], v[212:213], v[48:51]
    v_mfma_f32_16x16x16_bf16 v[52:55], v[232:233], v[212:213], v[52:55]
    s_waitcnt lgkmcnt(0)
    v_readfirstlane_b32 s64, v243
    v_mfma_f32_16x16x16_bf16 v[64:67], v[228:229], v[216:217], v[64:67]
    v_cvt_pk_bf16_f32 v100, v24, v25
    v_cvt_pk_bf16_f32 v101, v26, v27
    v_mfma_f32_16x16x16_bf16 v[68:71], v[230:231], v[216:217], v[68:71]
    v_cvt_pk_bf16_f32 v102, v28, v29
    v_cvt_pk_bf16_f32 v103, v30, v31
    v_mfma_f32_16x16x16_bf16 v[72:75], v[232:233], v[216:217], v[72:75]
    v_cvt_pk_bf16_f32 v104, v32, v33
    v_cvt_pk_bf16_f32 v105, v34, v35
    v_permlane16_swap_b32 v100, v102
    v_permlane16_swap_b32 v101, v103
    s_cmp_eq_u32 s64, 0
    s_cbranch_scc1 L_qs_42
    buffer_store_dwordx4 v[100:103], v240, s[16:19], s59 offen offset:0 sc1
    buffer_store_dwordx2 v[104:105], v241, s[16:19], s58 offen offset:1024 sc1
    s_branch L_qe_43
L_qs_42:
    buffer_store_dwordx4 v[100:103], v240, s[16:19], s59 offen offset:0
    buffer_store_dwordx2 v[104:105], v241, s[16:19], s58 offen offset:1024
L_qe_43:
    v_mfma_f32_16x16x16_bf16 v[84:87], v[228:229], v[220:221], v[84:87]
    v_cvt_pk_bf16_f32 v112, v44, v45
    v_cvt_pk_bf16_f32 v113, v46, v47
    v_mfma_f32_16x16x16_bf16 v[88:91], v[230:231], v[220:221], v[88:91]
    v_cvt_pk_bf16_f32 v114, v48, v49
    v_cvt_pk_bf16_f32 v115, v50, v51
    v_mfma_f32_16x16x16_bf16 v[92:95], v[232:233], v[220:221], v[92:95]
    v_cvt_pk_bf16_f32 v116, v52, v53
    v_cvt_pk_bf16_f32 v117, v54, v55
    v_permlane16_swap_b32 v112, v114
    v_permlane16_swap_b32 v113, v115
    s_cbranch_scc1 L_qs_44
    buffer_store_dwordx4 v[112:115], v240, s[16:19], s59 offen offset:256 sc1
    buffer_store_dwordx2 v[116:117], v241, s[16:19], s58 offen offset:1152 sc1
    s_branch L_qe_45
L_qs_44:
    buffer_store_dwordx4 v[112:115], v240, s[16:19], s59 offen offset:256
    buffer_store_dwordx2 v[116:117], v241, s[16:19], s58 offen offset:1152
L_qe_45:
    v_mfma_f32_16x16x16_bf16 v[16:19], v[224:225], v[208:209], v[16:19]
    v_cvt_pk_bf16_f32 v124, v64, v65
    v_cvt_pk_bf16_f32 v125, v66, v67
    v_mfma_f32_16x16x16_bf16 v[20:23], v[226:227], v[208:209], v[20:23]
    v_cvt_pk_bf16_f32 v126, v68, v69
    v_cvt_pk_bf16_f32 v127, v70, v71
    v_mfma_f32_16x16x16_bf16 v[36:39], v[224:225], v[212:213], v[36:39]
    v_cvt_pk_bf16_f32 v128, v72, v73
    v_cvt_pk_bf16_f32 v129, v74, v75
    v_mfma_f32_16x16x16_bf16 v[40:43], v[226:227], v[212:213], v[40:43]
    v_permlane16_swap_b32 v124, v126
    v_permlane16_swap_b32 v125, v127
    s_cbranch_scc1 L_qs_46
    buffer_store_dwordx4 v[124:127], v240, s[16:19], s59 offen offset:1280 sc1
    buffer_store_dwordx2 v[128:129], v241, s[16:19], s58 offen offset:2304 sc1
    s_branch L_qe_47
L_qs_46:
    buffer_store_dwordx4 v[124:127], v240, s[16:19], s59 offen offset:1280
    buffer_store_dwordx2 v[128:129], v241, s[16:19], s58 offen offset:2304
L_qe_47:
    v_mfma_f32_16x16x16_bf16 v[56:59], v[224:225], v[216:217], v[56:59]
    v_cvt_pk_bf16_f32 v136, v84, v85
    v_cvt_pk_bf16_f32 v137, v86, v87
    v_mfma_f32_16x16x16_bf16 v[60:63], v[226:227], v[216:217], v[60:63]
    v_cvt_pk_bf16_f32 v138, v88, v89
    v_cvt_pk_bf16_f32 v139, v90, v91
    v_mfma_f32_16x16x16_bf16 v[76:79], v[224:225], v[220:221], v[76:79]
    v_cvt_pk_bf16_f32 v140, v92, v93
    v_cvt_pk_bf16_f32 v141, v94, v95
    v_mfma_f32_16x16x16_bf16 v[80:83], v[226:227], v[220:221], v[80:83]
    v_permlane16_swap_b32 v136, v138
    v_permlane16_swap_b32 v137, v139
    s_cbranch_scc1 L_qs_48
    buffer_store_dwordx4 v[136:139], v240, s[16:19], s59 offen offset:1536 sc1
    buffer_store_dwordx2 v[140:141], v241, s[16:19], s58 offen offset:2432 sc1
    s_branch L_qe_49
L_qs_48:
    buffer_store_dwordx4 v[136:139], v240, s[16:19], s59 offen offset:1536
    buffer_store_dwordx2 v[140:141], v241, s[16:19], s58 offen offset:2432
L_qe_49:
    v_cvt_pk_bf16_f32 v96, v16, v17
    v_cvt_pk_bf16_f32 v97, v18, v19
    v_cvt_pk_bf16_f32 v98, v20, v21
    v_cvt_pk_bf16_f32 v99, v22, v23
    v_cvt_pk_bf16_f32 v108, v36, v37
    v_cvt_pk_bf16_f32 v109, v38, v39
    v_cvt_pk_bf16_f32 v110, v40, v41
    v_cvt_pk_bf16_f32 v111, v42, v43
    v_cvt_pk_bf16_f32 v120, v56, v57
    v_cvt_pk_bf16_f32 v121, v58, v59
    v_cvt_pk_bf16_f32 v122, v60, v61
    v_cvt_pk_bf16_f32 v123, v62, v63
    v_cvt_pk_bf16_f32 v132, v76, v77
    v_cvt_pk_bf16_f32 v133, v78, v79
    v_cvt_pk_bf16_f32 v134, v80, v81
    v_cvt_pk_bf16_f32 v135, v82, v83
    v_add_u32 v92, 158976, v7
    ds_read_b128 v[28:31], v92 offset:0
    ds_read_b128 v[32:35], v92 offset:1024
    ds_read_b128 v[36:39], v92 offset:2048
    v_permlane16_swap_b32 v96, v98
    v_permlane16_swap_b32 v97, v99
    v_permlane16_swap_b32 v108, v110
    v_permlane16_swap_b32 v109, v111
    v_permlane16_swap_b32 v120, v122
    v_permlane16_swap_b32 v121, v123
    v_permlane16_swap_b32 v132, v134
    v_permlane16_swap_b32 v133, v135
    s_waitcnt vmcnt(0)
    s_cbranch_scc1 L_qs_50
    s_mov_b64 exec, 1
    buffer_store_dword v0, off, s[16:19], s55 sc1
    s_mov_b64 exec, -1
    buffer_store_dwordx4 v[96:99], v240, s[16:19], s62 offen offset:0 sc1
    buffer_store_dwordx4 v[108:111], v240, s[16:19], s62 offen offset:256 sc1
    buffer_store_dwordx4 v[120:123], v240, s[16:19], s62 offen offset:1280 sc1
    buffer_store_dwordx4 v[132:135], v240, s[16:19], s62 offen offset:1536 sc1
    s_branch L_qe_51
L_qs_50:
    s_mov_b64 exec, 1
    buffer_store_dword v0, off, s[16:19], s55
    s_mov_b64 exec, -1
    buffer_store_dwordx4 v[96:99], v240, s[16:19], s62 offen offset:0
    buffer_store_dwordx4 v[108:111], v240, s[16:19], s62 offen offset:256
    buffer_store_dwordx4 v[120:123], v240, s[16:19], s62 offen offset:1280
    buffer_store_dwordx4 v[132:135], v240, s[16:19], s62 offen offset:1536
L_qe_51:
    s_barrier
    s_mov_b64 exec, 3
    buffer_load_dword v253, v252, s[16:19], s39 offen sc1
    s_mov_b64 exec, -1
    s_waitcnt vmcnt(0) lgkmcnt(0)
    s_cbranch_scc1 L_qs_52
    s_mov_b64 exec, 1
    buffer_store_dword v0, off, s[16:19], s56 sc1
    s_mov_b64 exec, -1
    s_branch L_qe_53
L_qs_52:
    s_mov_b64 exec, 1
    buffer_store_dword v0, off, s[16:19], s56
    s_mov_b64 exec, -1
L_qe_53:
    v_cmp_eq_u32 vcc, s52, v253
    s_cbranch_vccz L_opq
L_ophase:
    s_mov_b64 exec, 3
    s_mov_b32 s3, 0
L_poll_54:
    s_add_u32 s3, s3, 1
    s_cmp_gt_u32 s3, 200000
    s_cbranch_scc1 L_pdone_56
    buffer_load_dword v253, v252, s[16:19], s39 offen sc1
L_chk_55:
    s_waitcnt vmcnt(0)
    v_mov_b32 v92, v253
    v_cmp_eq_u32 vcc, s52, v92
    s_cbranch_vccnz L_poll_54
L_pdone_56:
    s_mov_b64 exec, -1
L_opq:
    buffer_load_dwordx4 v[16:19], v7, s[16:19], s38 offen sc1
    buffer_load_dwordx2 v[20:21], v1, s[16:19], s38 offen offset:1024 sc1
    buffer_load_dword v94, v255, s[16:19], 0 offen sc1
    s_add_u32 s3, s38, 10240
    buffer_load_dwordx4 v[22:25], v7, s[16:19], s3 offen sc1
    buffer_load_dwordx2 v[26:27], v1, s[16:19], s3 offen offset:1024 sc1
    buffer_load_dword v130, v255, s[16:19], 0 offen offset:1024 sc1
    s_mov_b32 s55, 0
    s_add_u32 s54, s40, 3584
    s_waitcnt vmcnt(0)
    v_mfma_f32_32x32x16_bf16 v[96:111], v[28:31], v[16:19], 0
    v_mfma_f32_32x32x8_bf16 v[96:111], v[36:37], v[20:21], v[96:111]
    v_mfma_f32_32x32x16_bf16 v[112:127], v[32:35], v[16:19], 0
    v_mfma_f32_32x32x8_bf16 v[112:127], v[38:39], v[20:21], v[112:127]
    v_mfma_f32_32x32x16_bf16 v[40:55], v[28:31], v[22:25], 0
    v_mfma_f32_32x32x8_bf16 v[40:55], v[36:37], v[26:27], v[40:55]
    v_mfma_f32_32x32x16_bf16 v[56:71], v[32:35], v[22:25], 0
    v_mfma_f32_32x32x8_bf16 v[56:71], v[38:39], v[26:27], v[56:71]
    s_cmp_lt_u32 s4, 4
    s_cbranch_scc1 L_op1
    s_add_u32 m0, s97, 0
    s_add_u32 s65, s96, 0
    buffer_load_dwordx4 v224, s[20:23], s65 offen offset:0 lds
    buffer_load_dwordx4 v225, s[20:23], s65 offen offset:1024 lds
    buffer_load_dwordx4 v226, s[20:23], s65 offen offset:2048 lds
    buffer_load_dwordx4 v227, s[20:23], s65 offen offset:3072 lds
    s_add_u32 m0, m0, 4096
    s_nop 0
    buffer_load_dwordx4 v228, s[20:23], s65 offen lds
    s_add_u32 m0, s99, 20480
    s_add_u32 s65, s98, 163840
    buffer_load_dwordx4 v224, s[20:23], s65 offen offset:0 lds
    buffer_load_dwordx4 v225, s[20:23], s65 offen offset:1024 lds
    buffer_load_dwordx4 v226, s[20:23], s65 offen offset:2048 lds
    buffer_load_dwordx4 v227, s[20:23], s65 offen offset:3072 lds
    s_add_u32 m0, m0, 4096
    s_nop 0
    buffer_load_dwordx4 v228, s[20:23], s65 offen lds
    s_add_u32 m0, s97, 40960
    s_add_u32 s65, s96, 327680
    buffer_load_dwordx4 v224, s[20:23], s65 offen offset:0 lds
    buffer_load_dwordx4 v225, s[20:23], s65 offen offset:1024 lds
    buffer_load_dwordx4 v226, s[20:23], s65 offen offset:2048 lds
    buffer_load_dwordx4 v227, s[20:23], s65 offen offset:3072 lds
    s_add_u32 m0, m0, 4096
    s_nop 0
    buffer_load_dwordx4 v228, s[20:23], s65 offen lds
L_op1:
    v_mov_b32 v128, v94
    v_and_b32 v128, 0xffff0000, v128
    v_rcp_f32 v128, v128
    s_nop 0
    v_mul_f32 v128, 0x3fb8aa3b, v128
    v_and_b32 v130, 0xffff0000, v130
    v_rcp_f32 v130, v130
    s_nop 0
    v_mul_f32 v130, 0x3fb8aa3b, v130
    v_max3_f32 v92, v96, v97, v98
    v_max3_f32 v93, v99, v100, v101
    v_max3_f32 v92, v92, v102, v103
    v_max3_f32 v93, v93, v104, v105
    v_max3_f32 v92, v92, v106, v107
    v_max3_f32 v93, v93, v108, v109
    v_max3_f32 v92, v92, v110, v111
    v_max3_f32 v93, v93, v112, v113
    v_max3_f32 v92, v92, v114, v115
    v_max_f32 v92, v92, v93
    v_mul_f32 v129, v128, v92
    v_max3_f32 v92, v40, v41, v42
    v_max3_f32 v93, v43, v44, v45
    v_max3_f32 v92, v92, v46, v47
    v_max3_f32 v93, v93, v48, v49
    v_max3_f32 v92, v92, v50, v51
    v_max3_f32 v93, v93, v52, v53
    v_max3_f32 v92, v92, v54, v55
    v_max3_f32 v93, v93, v56, v57
    v_max3_f32 v92, v92, v58, v59
    v_max_f32 v92, v92, v93
    v_mul_f32 v131, v130, v92
    v_fma_f32 v96, v96, v128, -v129
    v_fma_f32 v97, v97, v128, -v129
    v_fma_f32 v98, v98, v128, -v129
    v_fma_f32 v99, v99, v128, -v129
    v_fma_f32 v100, v100, v128, -v129
    v_fma_f32 v101, v101, v128, -v129
    v_fma_f32 v102, v102, v128, -v129
    v_fma_f32 v103, v103, v128, -v129
    v_fma_f32 v104, v104, v128, -v129
    v_fma_f32 v105, v105, v128, -v129
    v_fma_f32 v106, v106, v128, -v129
    v_fma_f32 v107, v107, v128, -v129
    v_fma_f32 v108, v108, v128, -v129
    v_fma_f32 v109, v109, v128, -v129
    v_fma_f32 v110, v110, v128, -v129
    v_fma_f32 v111, v111, v128, -v129
    v_fma_f32 v112, v112, v128, -v129
    v_fma_f32 v113, v113, v128, -v129
    v_fma_f32 v114, v114, v128, -v129
    v_fma_f32 v115, v115, v128, -v129
    v_exp_f32 v96, v96
    v_exp_f32 v97, v97
    v_exp_f32 v98, v98
    v_exp_f32 v99, v99
    v_exp_f32 v100, v100
    v_exp_f32 v101, v101
    v_exp_f32 v102, v102
    v_exp_f32 v103, v103
    v_exp_f32 v104, v104
    v_exp_f32 v105, v105
    v_exp_f32 v106, v106
    v_exp_f32 v107, v107
    v_exp_f32 v108, v108
    v_exp_f32 v109, v109
    v_exp_f32 v110, v110
    v_exp_f32 v111, v111
    v_exp_f32 v112, v112
    v_exp_f32 v113, v113
    v_exp_f32 v114, v114
    v_exp_f32 v115, v115
    v_pk_add_f32 v[92:93], v[96:97], v[98:99]
    v_pk_add_f32 v[94:95], v[100:101], v[102:103]
    v_pk_add_f32 v[92:93], v[92:93], v[104:105]
    v_pk_add_f32 v[94:95], v[94:95], v[106:107]
    v_pk_add_f32 v[92:93], v[92:93], v[108:109]
    v_pk_add_f32 v[94:95], v[94:95], v[110:111]
    v_pk_add_f32 v[92:93], v[92:93], v[112:113]
    v_pk_add_f32 v[94:95], v[94:95], v[114:115]
    v_pk_add_f32 v[92:93], v[92:93], v[94:95]
    v_add_f32 v92, v92, v93
    v_rcp_f32 v92, v92
    s_nop 0
    v_pk_mul_f32 v[96:97], v[96:97], v[92:93] op_sel_hi:[1,0]
    v_pk_mul_f32 v[98:99], v[98:99], v[92:93] op_sel_hi:[1,0]
    v_pk_mul_f32 v[100:101], v[100:101], v[92:93] op_sel_hi:[1,0]
    v_pk_mul_f32 v[102:103], v[102:103], v[92:93] op_sel_hi:[1,0]
    v_pk_mul_f32 v[104:105], v[104:105], v[92:93] op_sel_hi:[1,0]
    v_pk_mul_f32 v[106:107], v[106:107], v[92:93] op_sel_hi:[1,0]
    v_pk_mul_f32 v[108:109], v[108:109], v[92:93] op_sel_hi:[1,0]
    v_pk_mul_f32 v[110:111], v[110:111], v[92:93] op_sel_hi:[1,0]
    v_pk_mul_f32 v[112:113], v[112:113], v[92:93] op_sel_hi:[1,0]
    v_pk_mul_f32 v[114:115], v[114:115], v[92:93] op_sel_hi:[1,0]
    v_cvt_pk_bf16_f32 v82, v96, v97
    v_cvt_pk_bf16_f32 v83, v98, v99
    v_cvt_pk_bf16_f32 v84, v100, v101
    v_cvt_pk_bf16_f32 v85, v102, v103
    v_cvt_pk_bf16_f32 v86, v104, v105
    v_cvt_pk_bf16_f32 v87, v106, v107
    v_cvt_pk_bf16_f32 v88, v108, v109
    v_cvt_pk_bf16_f32 v89, v110, v111
    v_cvt_pk_bf16_f32 v90, v112, v113
    v_cvt_pk_bf16_f32 v91, v114, v115
    s_cmp_lt_u32 s4, 4
    s_cbranch_scc1 L_op2
    s_add_u32 m0, s99, 61440
    s_add_u32 s65, s98, 491520
    buffer_load_dwordx4 v224, s[20:23], s65 offen offset:0 lds
    buffer_load_dwordx4 v225, s[20:23], s65 offen offset:1024 lds
    buffer_load_dwordx4 v226, s[20:23], s65 offen offset:2048 lds
    buffer_load_dwordx4 v227, s[20:23], s65 offen offset:3072 lds
    s_add_u32 m0, m0, 4096
    s_nop 0
    buffer_load_dwordx4 v228, s[20:23], s65 offen lds
L_op2:
    s_cmp_eq_u32 s4, 7
    s_cbranch_scc0 L_op5
    s_mov_b64 exec, 1
    v_mov_b32 v18, 0
    buffer_atomic_or v18, v0, s[16:19], s44 offen sc0 sc1
    s_mov_b64 exec, -1
L_op5:
    v_pk_fma_f32 v[40:41], v[40:41], v[130:131], v[130:131] op_sel:[0,0,1] op_sel_hi:[1,0,1] neg_lo:[0,0,1] neg_hi:[0,0,1]
    v_pk_fma_f32 v[42:43], v[42:43], v[130:131], v[130:131] op_sel:[0,0,1] op_sel_hi:[1,0,1] neg_lo:[0,0,1] neg_hi:[0,0,1]
    v_pk_fma_f32 v[44:45], v[44:45], v[130:131], v[130:131] op_sel:[0,0,1] op_sel_hi:[1,0,1] neg_lo:[0,0,1] neg_hi:[0,0,1]
    v_pk_fma_f32 v[46:47], v[46:47], v[130:131], v[130:131] op_sel:[0,0,1] op_sel_hi:[1,0,1] neg_lo:[0,0,1] neg_hi:[0,0,1]
    v_pk_fma_f32 v[48:49], v[48:49], v[130:131], v[130:131] op_sel:[0,0,1] op_sel_hi:[1,0,1] neg_lo:[0,0,1] neg_hi:[0,0,1]
    v_pk_fma_f32 v[50:51], v[50:51], v[130:131], v[130:131] op_sel:[0,0,1] op_sel_hi:[1,0,1] neg_lo:[0,0,1] neg_hi:[0,0,1]
    v_pk_fma_f32 v[52:53], v[52:53], v[130:131], v[130:131] op_sel:[0,0,1] op_sel_hi:[1,0,1] neg_lo:[0,0,1] neg_hi:[0,0,1]
    v_pk_fma_f32 v[54:55], v[54:55], v[130:131], v[130:131] op_sel:[0,0,1] op_sel_hi:[1,0,1] neg_lo:[0,0,1] neg_hi:[0,0,1]
    v_pk_fma_f32 v[56:57], v[56:57], v[130:131], v[130:131] op_sel:[0,0,1] op_sel_hi:[1,0,1] neg_lo:[0,0,1] neg_hi:[0,0,1]
    v_pk_fma_f32 v[58:59], v[58:59], v[130:131], v[130:131] op_sel:[0,0,1] op_sel_hi:[1,0,1] neg_lo:[0,0,1] neg_hi:[0,0,1]
    v_exp_f32 v40, v40
    v_exp_f32 v41, v41
    v_exp_f32 v42, v42
    v_exp_f32 v43, v43
    v_exp_f32 v44, v44
    v_exp_f32 v45, v45
    v_exp_f32 v46, v46
    v_exp_f32 v47, v47
    v_exp_f32 v48, v48
    v_exp_f32 v49, v49
    v_exp_f32 v50, v50
    v_exp_f32 v51, v51
    v_exp_f32 v52, v52
    v_exp_f32 v53, v53
    v_exp_f32 v54, v54
    v_exp_f32 v55, v55
    v_exp_f32 v56, v56
    v_exp_f32 v57, v57
    v_exp_f32 v58, v58
    v_exp_f32 v59, v59
    v_pk_add_f32 v[92:93], v[40:41], v[42:43]
    v_pk_add_f32 v[94:95], v[44:45], v[46:47]
    v_pk_add_f32 v[92:93], v[92:93], v[48:49]
    v_pk_add_f32 v[94:95], v[94:95], v[50:51]
    v_pk_add_f32 v[92:93], v[92:93], v[52:53]
    v_pk_add_f32 v[94:95], v[94:95], v[54:55]
    v_pk_add_f32 v[92:93], v[92:93], v[56:57]
    v_pk_add_f32 v[94:95], v[94:95], v[58:59]
    v_pk_add_f32 v[92:93], v[92:93], v[94:95]
    v_add_f32 v92, v92, v93
    v_rcp_f32 v92, v92
    s_nop 0
    v_pk_mul_f32 v[40:41], v[40:41], v[92:93] op_sel_hi:[1,0]
    v_pk_mul_f32 v[42:43], v[42:43], v[92:93] op_sel_hi:[1,0]
    v_pk_mul_f32 v[44:45], v[44:45], v[92:93] op_sel_hi:[1,0]
    v_pk_mul_f32 v[46:47], v[46:47], v[92:93] op_sel_hi:[1,0]
    v_pk_mul_f32 v[48:49], v[48:49], v[92:93] op_sel_hi:[1,0]
    v_pk_mul_f32 v[50:51], v[50:51], v[92:93] op_sel_hi:[1,0]
    v_pk_mul_f32 v[52:53], v[52:53], v[92:93] op_sel_hi:[1,0]
    v_pk_mul_f32 v[54:55], v[54:55], v[92:93] op_sel_hi:[1,0]
    v_pk_mul_f32 v[56:57], v[56:57], v[92:93] op_sel_hi:[1,0]
    v_pk_mul_f32 v[58:59], v[58:59], v[92:93] op_sel_hi:[1,0]
    v_cvt_pk_bf16_f32 v72, v40, v41
    v_cvt_pk_bf16_f32 v73, v42, v43
    v_cvt_pk_bf16_f32 v74, v44, v45
    v_cvt_pk_bf16_f32 v75, v46, v47
    v_cvt_pk_bf16_f32 v76, v48, v49
    v_cvt_pk_bf16_f32 v77, v50, v51
    v_cvt_pk_bf16_f32 v78, v52, v53
    v_cvt_pk_bf16_f32 v79, v54, v55
    v_cvt_pk_bf16_f32 v80, v56, v57
    v_cvt_pk_bf16_f32 v81, v58, v59
    s_cmp_lt_u32 s4, 4
    s_cbranch_scc0 L_op3
    s_mov_b32 s70, 6144
    v_mov_b64 v[230:231], 0
    s_mov_b64 exec, 1
    buffer_load_dwordx2 v[230:231], off, s[16:19], s70 sc1
    s_mov_b64 exec, -1
    s_lshr_b32 s3, s6, 3
    s_lshl2_add_u32 s3, s5, s3
    s_lshl2_add_u32 s3, s3, s4
    s_lshl_b32 s3, s3, 6
    s_add_u32 s49, s3, 8192
    v_and_b32 v4, 15, v0
    v_lshlrev_b32 v4, 2, v4
    buffer_load_dword v229, v4, s[16:19], s49 offen sc1
    s_branch L_kvwait
L_op3:
    s_cmp_eq_u32 s4, 7
    s_cbranch_scc1 L_op4
    s_waitcnt vmcnt(0)
    s_branch L_kvwait
L_op4:
L_phix:
    s_lshl_b32 s56, s5, 7
    s_add_u32 s56, s56, 4096
    v_lshlrev_b32 v16, 10, v0
    v_mov_b32 v21, 0xff81ffa1
    s_mov_b64 exec, 1
    v_mov_b32 v19, 0
    buffer_atomic_or v19, v0, s[16:19], s44 offen sc0 sc1
    s_mov_b64 exec, -1
    s_mov_b64 exec, 3
    v_mov_b32 v21, 0
    buffer_atomic_or v21, v16, s[16:19], s56 offen sc0 sc1
    s_mov_b64 exec, -1
    v_and_b32 v56, 31, v0
    v_min_u32 v56, 20, v56
    v_lshrrev_b32 v57, 5, v0
    v_mov_b32 v58, 0x7ff00000
    v_mul_u32_u24 v59, 21, v57
    v_add_u32 v56, v56, v59
    s_mov_b32 s3, 156928
    v_lshl_add_u32 v23, v56, 3, s3
    v_lshl_add_u32 v22, v56, 4, s3
    v_bfe_u32 v12, v0, 4, 1
    v_mul_u32_u24 v12, 20480, v12
    v_and_b32 v56, 15, v0
    v_cmp_gt_u32 vcc, 32, v0
    v_lshl_add_u32 v13, v56, 3, v12
    v_lshl_add_u32 v12, v56, 4, v12
    v_lshl_add_u32 v12, v57, 8, v12
    v_cndmask_b32 v13, v58, v13, vcc
    s_lshr_b32 s3, s6, 3
    s_lshl3_add_u32 s50, s5, s3
    s_lshl_b32 s50, s50, 7
    s_add_u32 s50, s50, 57344
    s_lshl2_add_u32 s3, s5, s3
    s_and_b32 s53, s4, 3
    s_lshl2_add_u32 s51, s3, s53
    s_mul_i32 s48, s51, 20480
    s_add_u32 s45, s48, 4268032
    s_add_u32 s46, s45, 4096
    s_add_u32 s47, s48, 4278272
    s_and_b32 s3, s6, 7
    s_mul_i32 s3, s3, 160
    s_add_u32 s48, s48, s3
    v_lshlrev_b32 v7, 4, v0
    v_lshrrev_b32 v56, 4, v0
    v_bfe_u32 v57, v0, 2, 2
    v_and_b32 v58, 3, v0
    v_mul_u32_u24 v57, 160, v57
    v_lshl_add_u32 v57, v58, 3, v57
    v_add_u32 v57, 51200, v57
    v_lshrrev_b32 v58, 5, v0
    v_mul_u32_u24 v58, 3200, v58
    v_and_b32 v6, 1, v56
    v_mul_u32_u24 v6, 640, v6
    v_add3_u32 v6, v6, v58, v57
    v_mul_u32_u24 v2, 3200, v56
    v_add_u32 v2, v2, v57
    s_mul_i32 s3, s53, 2560
    s_add_u32 s3, s3, 133120
    v_and_b32 v57, 15, v0
    v_mul_u32_u24 v3, 160, v57
    v_lshl_add_u32 v3, v56, 3, v3
    v_add_u32 v3, s3, v3
    v_add_u32 v11, s3, v7
    s_mul_i32 s3, s53, 5120
    s_add_u32 s3, s3, 112640
    v_add_u32 v5, s3, v7
    v_mul_u32_u24 v56, 6554, v0
    s_movk_i32 s3, 1120
    v_cmp_gt_u32 vcc, 32, v0
    v_lshrrev_b32 v57, 16, v56
    v_mad_u32_u24 v8, v57, s3, v7
    v_add_u32 v56, 419456, v56
    v_lshrrev_b32 v57, 16, v56
    v_mad_u32_u24 v9, v57, s3, v7
    v_add_u32 v56, 419456, v56
    v_lshrrev_b32 v57, 16, v56
    v_mad_u32_u24 v10, v57, s3, v7
    v_mov_b32 v56, 0x7ff00000
    v_cndmask_b32 v10, v56, v10, vcc
    v_lshlrev_b32 v4, 9, v0
    v_lshrrev_b32 v14, 2, v0
    v_lshlrev_b32 v14, 9, v14
    v_lshl_add_u32 v14, v0, 7, v14
    v_mov_b32 v15, 1
    s_waitcnt vmcnt(2)
    v_readfirstlane_b32 s3, v18
    s_nop 0
    s_cmp_eq_u32 s3, 0xff81ff91
    s_cbranch_scc1 L_kgo
    s_waitcnt vmcnt(0)
    v_readfirstlane_b32 s3, v19
    s_nop 0
    s_cmp_eq_u32 s3, 0xff81ff91
    s_cbranch_scc1 L_kgo
    s_mov_b64 exec, 0x1
    s_mov_b32 s3, 0
L_cp_57:
    v_mov_b32 v18, 0
    s_add_u32 s3, s3, 1
    s_cmp_gt_u32 s3, 200000
    s_cbranch_scc1 L_cdone_58
    buffer_atomic_or v18, v0, s[16:19], s44 offen sc0 sc1
    s_waitcnt vmcnt(0)
    v_cmp_ne_u32 vcc, 0xff81ff91, v18
    s_cbranch_vccnz L_cp_57
L_cdone_58:
    s_mov_b64 exec, -1
L_kgo:
    s_barrier
    s_cmp_lt_u32 s57, 8
    s_cselect_b64 s[54:55], 15, 0xff
    s_waitcnt vmcnt(0)
    v_cmp_ne_u32 vcc, 0xff81ffa1, v21
    s_cbranch_vccz L_wl1
    s_mov_b64 exec, 0x3
    s_mov_b32 s3, 0
L_cp_59:
    v_mov_b32 v21, 0
    s_add_u32 s3, s3, 1
    s_cmp_gt_u32 s3, 200000
    s_cbranch_scc1 L_cdone_60
    buffer_atomic_or v21, v16, s[16:19], s56 offen sc0 sc1
    s_waitcnt vmcnt(0)
    v_cmp_ne_u32 vcc, 0xff81ffa1, v21
    s_cbranch_vccnz L_cp_59
L_cdone_60:
    s_mov_b64 exec, -1
L_wl1:
    s_add_u32 s68, s68, 532480
    s_sub_u32 s67, s67, 122880
    s_mov_b32 s69, 0
    s_add_u32 m0, s69, 81920
    s_nop 0
    buffer_load_dwordx4 v224, s[20:23], s68 offen offset:0 lds
    buffer_load_dwordx4 v225, s[20:23], s68 offen offset:1024 lds
    buffer_load_dwordx4 v226, s[20:23], s68 offen offset:2048 lds
    buffer_load_dwordx4 v227, s[20:23], s68 offen offset:3072 lds
    s_add_u32 m0, m0, 4096
    s_nop 0
    buffer_load_dwordx4 v228, s[20:23], s68 offen lds
    s_add_u32 s68, s68, 40960
    s_add_u32 m0, s69, 87040
    s_nop 0
    buffer_load_dwordx4 v224, s[20:23], s68 offen offset:0 lds
    buffer_load_dwordx4 v225, s[20:23], s68 offen offset:1024 lds
    buffer_load_dwordx4 v226, s[20:23], s68 offen offset:2048 lds
    buffer_load_dwordx4 v227, s[20:23], s68 offen offset:3072 lds
    s_add_u32 m0, m0, 4096
    s_nop 0
    buffer_load_dwordx4 v228, s[20:23], s68 offen lds
    s_add_u32 s68, s68, 40960
    s_add_u32 m0, s69, 92160
    s_nop 0
    buffer_load_dwordx4 v224, s[20:23], s68 offen offset:0 lds
    buffer_load_dwordx4 v225, s[20:23], s68 offen offset:1024 lds
    buffer_load_dwordx4 v226, s[20:23], s68 offen offset:2048 lds
    buffer_load_dwordx4 v227, s[20:23], s68 offen offset:3072 lds
    s_add_u32 m0, m0, 4096
    s_nop 0
    buffer_load_dwordx4 v228, s[20:23], s68 offen lds
    s_add_u32 s68, s68, 40960
    s_add_u32 m0, s69, 97280
    s_nop 0
    buffer_load_dwordx4 v224, s[20:23], s68 offen offset:0 lds
    buffer_load_dwordx4 v225, s[20:23], s68 offen offset:1024 lds
    buffer_load_dwordx4 v226, s[20:23], s68 offen offset:2048 lds
    buffer_load_dwordx4 v227, s[20:23], s68 offen offset:3072 lds
    s_add_u32 m0, m0, 4096
    s_nop 0
    buffer_load_dwordx4 v228, s[20:23], s68 offen lds
    s_add_u32 s68, s68, 40960
    s_add_u32 m0, s69, 102400
    s_nop 0
    buffer_load_dwordx4 v224, s[8:11], s67 offen offset:0 lds
    buffer_load_dwordx4 v225, s[8:11], s67 offen offset:1024 lds
    buffer_load_dwordx4 v226, s[8:11], s67 offen offset:2048 lds
    buffer_load_dwordx4 v227, s[8:11], s67 offen offset:3072 lds
    s_add_u32 m0, m0, 4096
    s_nop 0
    buffer_load_dwordx4 v228, s[8:11], s67 offen lds
    s_add_u32 s67, s67, 40960
    s_add_u32 m0, s69, 107520
    s_nop 0
    buffer_load_dwordx4 v224, s[8:11], s67 offen offset:0 lds
    buffer_load_dwordx4 v225, s[8:11], s67 offen offset:1024 lds
    buffer_load_dwordx4 v226, s[8:11], s67 offen offset:2048 lds
    buffer_load_dwordx4 v227, s[8:11], s67 offen offset:3072 lds
    s_add_u32 m0, m0, 4096
    s_nop 0
    buffer_load_dwordx4 v228, s[8:11], s67 offen lds
    s_add_u32 s67, s67, 40960
    s_branch L_kred
L_o2:
    s_waitcnt lgkmcnt(2)
    v_mfma_f32_32x32x16_bf16 v[56:71], v[28:31], v[82:85], 0
    s_waitcnt lgkmcnt(1)
    v_mfma_f32_32x32x16_bf16 v[56:71], v[32:35], v[86:89], v[56:71]
    s_waitcnt lgkmcnt(0)
    v_mfma_f32_32x32x8_bf16 v[56:71], v[36:37], v[90:91], v[56:71]
    v_mfma_f32_32x32x16_bf16 v[40:55], v[28:31], v[72:75], 0
    v_mfma_f32_32x32x16_bf16 v[40:55], v[32:35], v[76:79], v[40:55]
    s_nop 9
    v_add_f32 v17, 0x358637bd, v68
    v_rcp_f32 v17, v17
    s_nop 0
    v_mul_f32 v56, v56, v17
    v_mul_f32 v57, v57, v17
    v_mul_f32 v58, v58, v17
    v_mul_f32 v59, v59, v17
    v_mfma_f32_32x32x8_bf16 v[40:55], v[36:37], v[80:81], v[40:55]
    v_mul_f32 v60, v60, v17
    v_mul_f32 v61, v61, v17
    v_mul_f32 v62, v62, v17
    v_mul_f32 v63, v63, v17
    v_cvt_pk_bf16_f32 v24, v56, v57
    v_cvt_pk_bf16_f32 v25, v58, v59
    v_cvt_pk_bf16_f32 v26, v60, v61
    v_cvt_pk_bf16_f32 v27, v62, v63
    buffer_store_dwordx4 v[24:27], v12, s[16:19], s41 offen sc1
    v_mul_f32 v64, v64, v17
    v_mul_f32 v65, v65, v17
    v_mul_f32 v66, v66, v17
    v_mul_f32 v67, v67, v17
    v_cvt_pk_bf16_f32 v28, v64, v65
    v_cvt_pk_bf16_f32 v29, v66, v67
    buffer_store_dwordx2 v[28:29], v13, s[16:19], s42 offen sc1
    s_add_u32 s41, s41, 327680
    s_add_u32 s42, s42, 327680
    s_branch L_o1
    .p2align 12
L_helper:
    s_load_dwordx2 s[36:37], s[0:1], 40
    s_load_dwordx2 s[40:41], s[0:1], 48
    s_load_dwordx2 s[44:45], s[0:1], 56
    s_load_dwordx2 s[48:49], s[0:1], 64
    s_mov_b32 s38, 1280
    s_mov_b32 s39, 0x20000
    s_sub_u32 s54, s7, 24
    s_lshl3_add_u32 s55, s5, s54
    s_lshl3_add_u32 s56, s55, s4
    v_lshrrev_b32 v3, 4, v0
    v_and_b32 v4, 15, v0
    v_lshlrev_b32 v4, 4, v4
    s_lshl_b32 s3, s56, 2
    v_add_u32 v5, s3, v3
    s_movk_i32 s3, 1280
    v_mad_u32_u24 v6, v5, s3, v4
    s_bfe_u32 s58, s5, 0x10001
    s_lshr_b32 s59, s5, 2
    s_bitcmp0_b32 s5, 0
    s_mov_b32 s60, 0xfced9843
    s_cselect_b32 s60, 0x72ba6510, s60
    s_lshl_b32 s3, s54, 2
    s_lshr_b32 s60, s60, s3
    s_and_b32 s60, s60, 15
    s_mul_i32 s3, s60, 52
    s_lshr_b32 s3, s3, 8
    s_add_u32 s3, s3, s58
    s_mul_i32 s3, s3, 640
    s_lshl_b32 s61, s60, 7
    s_add_u32 s61, s61, s3
    s_lshr_b32 s3, s4, 2
    s_lshl1_add_u32 s3, s3, s59
    s_and_b32 s53, s4, 3
    s_lshl2_add_u32 s3, s3, s53
    s_mul_i32 s3, s3, 30720
    s_add_u32 s3, s3, s61
    s_cmp_eq_u32 s60, 15
    s_cselect_b32 s3, 0x7ff00000, s3
    v_lshrrev_b32 v7, 3, v0
    v_mul_u32_u24 v7, 3840, v7
    v_and_b32 v8, 7, v0
    v_lshl_add_u32 v7, v8, 4, v7
    v_add_u32 v7, s3, v7
    s_waitcnt lgkmcnt(0)
    buffer_load_dwordx4 v[20:23], v6, s[8:11], 0 offen offset:256
    s_mov_b32 s62, 491520
    buffer_load_dwordx4 v[40:43], v7, s[12:15], s62 offen
    s_barrier
    buffer_load_dwordx4 v[24:27], v6, s[8:11], 0 offen offset:512
    s_mov_b32 s62, 983040
    buffer_load_dwordx4 v[44:47], v7, s[12:15], s62 offen
    s_barrier
    buffer_load_dwordx4 v[28:31], v6, s[8:11], 0 offen offset:768
    buffer_load_dwordx4 v[32:35], v6, s[8:11], 0 offen offset:1024
    buffer_load_dwordx4 v[16:19], v6, s[8:11], 0 offen offset:0
    buffer_load_dwordx4 v[56:59], v4, s[36:39], 0 offen offset:0
    buffer_load_dwordx4 v[60:63], v4, s[36:39], 0 offen offset:256
    buffer_load_dwordx4 v[64:67], v4, s[36:39], 0 offen offset:512
    buffer_load_dwordx4 v[68:71], v4, s[36:39], 0 offen offset:768
    buffer_load_dwordx4 v[72:75], v4, s[36:39], 0 offen offset:1024
    s_mov_b32 s42, 1966080
    s_mov_b32 s43, 0x20000
    s_mov_b32 s18, 268435456
    s_mov_b32 s19, 0x20000
    s_mov_b32 s34, 25600
    s_mov_b32 s35, 0x20000
    s_mov_b32 s22, 819200
    s_mov_b32 s23, 0x20000
    s_mov_b32 s26, 2621440
    s_mov_b32 s27, 0x20000
    s_mov_b32 s30, 256
    s_mov_b32 s31, 0x20000
    s_mov_b32 s52, 0xff81ff81
    v_lshlrev_b32 v2, 4, v0
    v_mov_b32 v12, s52
    v_mov_b32 v13, s52
    v_mov_b32 v14, s52
    v_mov_b32 v15, s52
    s_mul_i32 s62, s56, 3072
    s_add_u32 s62, s62, 2686976
    buffer_store_dwordx4 v[12:15], v2, s[16:19], s62 offen offset:0 sc1
    buffer_store_dwordx4 v[12:15], v2, s[16:19], s62 offen offset:1024 sc1
    buffer_store_dwordx4 v[12:15], v2, s[16:19], s62 offen offset:2048 sc1
    v_lshrrev_b32 v130, 3, v0
    v_mul_u32_u24 v130, 3072, v130
    v_lshl_add_u32 v130, v8, 4, v130
    s_cmp_ge_u32 s4, 3
    s_cselect_b32 s64, 3, 0
    s_cselect_b64 s[40:41], s[44:45], s[40:41]
    s_sub_u32 s65, s4, s64
    s_mul_i32 s68, s54, 245760
    s_mul_i32 s3, s5, 384
    s_add_u32 s68, s68, s3
    s_lshl_b32 s3, s65, 7
    s_add_u32 s68, s68, s3
    s_mul_i32 s69, s4, 10240
    s_movk_i32 s70, 24576
    s_movk_i32 s71, 1024
    s_mov_b32 s67, -1
    s_cmp_lt_u32 s4, 6
    s_cbranch_scc1 L_hsw
    s_mov_b64 s[40:41], s[48:49]
    v_mul_u32_u24 v130, 6554, v0
    v_lshrrev_b32 v130, 16, v130
    v_mul_u32_u24 v130, 1120, v130
    v_add_u32 v130, v130, v2
    s_sub_u32 s3, 7, s4
    s_mul_i32 s69, s3, 3840
    s_add_u32 s69, s69, 112640
    s_mul_i32 s3, s3, 30720
    s_mul_i32 s68, s5, 245760
    s_add_u32 s68, s68, s3
    s_mul_i32 s3, s54, 160
    s_add_u32 s68, s68, s3
    s_movk_i32 s70, 7680
    s_movk_i32 s71, 960
    s_mov_b32 s67, 0x0fffffff
L_hsw:
    v_and_b32 v117, 31, v0
    v_lshlrev_b32 v117, 3, v117
    s_waitcnt vmcnt(8)
    s_mov_b32 s62, 1474560
    buffer_load_dwordx4 v[48:51], v7, s[12:15], s62 offen
    v_lshlrev_b32 v76, 16, v16
    v_and_b32 v77, 0xffff0000, v16
    v_lshlrev_b32 v78, 16, v17
    v_and_b32 v79, 0xffff0000, v17
    v_lshlrev_b32 v80, 16, v18
    v_and_b32 v81, 0xffff0000, v18
    v_lshlrev_b32 v82, 16, v19
    v_and_b32 v83, 0xffff0000, v19
    v_lshlrev_b32 v84, 16, v20
    v_and_b32 v85, 0xffff0000, v20
    v_lshlrev_b32 v86, 16, v21
    v_and_b32 v87, 0xffff0000, v21
    v_lshlrev_b32 v88, 16, v22
    v_and_b32 v89, 0xffff0000, v22
    v_lshlrev_b32 v90, 16, v23
    v_and_b32 v91, 0xffff0000, v23
    v_lshlrev_b32 v92, 16, v24
    v_and_b32 v93, 0xffff0000, v24
    v_lshlrev_b32 v94, 16, v25
    v_and_b32 v95, 0xffff0000, v25
    v_lshlrev_b32 v96, 16, v26
    v_and_b32 v97, 0xffff0000, v26
    v_lshlrev_b32 v98, 16, v27
    v_and_b32 v99, 0xffff0000, v27
    v_lshlrev_b32 v100, 16, v28
    v_and_b32 v101, 0xffff0000, v28
    v_lshlrev_b32 v102, 16, v29
    v_and_b32 v103, 0xffff0000, v29
    v_lshlrev_b32 v104, 16, v30
    v_and_b32 v105, 0xffff0000, v30
    v_lshlrev_b32 v106, 16, v31
    v_and_b32 v107, 0xffff0000, v31
    v_lshlrev_b32 v108, 16, v32
    v_and_b32 v109, 0xffff0000, v32
    v_lshlrev_b32 v110, 16, v33
    v_and_b32 v111, 0xffff0000, v33
    v_lshlrev_b32 v112, 16, v34
    v_and_b32 v113, 0xffff0000, v34
    v_lshlrev_b32 v114, 16, v35
    v_and_b32 v115, 0xffff0000, v35
    v_pk_add_f32 v[120:121], v[76:77], v[78:79]
    v_pk_add_f32 v[122:123], v[80:81], v[82:83]
    v_pk_add_f32 v[120:121], v[120:121], v[84:85]
    v_pk_add_f32 v[122:123], v[122:123], v[86:87]
    v_pk_add_f32 v[120:121], v[120:121], v[88:89]
    v_pk_add_f32 v[122:123], v[122:123], v[90:91]
    v_pk_add_f32 v[120:121], v[120:121], v[92:93]
    v_pk_add_f32 v[122:123], v[122:123], v[94:95]
    v_pk_add_f32 v[120:121], v[120:121], v[96:97]
    v_pk_add_f32 v[122:123], v[122:123], v[98:99]
    v_pk_add_f32 v[120:121], v[120:121], v[100:101]
    v_pk_add_f32 v[122:123], v[122:123], v[102:103]
    v_pk_add_f32 v[120:121], v[120:121], v[104:105]
    v_pk_add_f32 v[122:123], v[122:123], v[106:107]
    v_pk_add_f32 v[120:121], v[120:121], v[108:109]
    v_pk_add_f32 v[122:123], v[122:123], v[110:111]
    v_pk_add_f32 v[120:121], v[120:121], v[112:113]
    v_pk_add_f32 v[122:123], v[122:123], v[114:115]
    v_pk_add_f32 v[120:121], v[120:121], v[122:123]
    v_add_f32 v120, v120, v121
    s_nop 1
    v_add_f32_dpp v120, v120, v120 row_ror:8 row_mask:0xf bank_mask:0xf
    s_nop 1
    v_add_f32_dpp v120, v120, v120 row_ror:4 row_mask:0xf bank_mask:0xf
    s_nop 1
    v_add_f32_dpp v120, v120, v120 row_ror:2 row_mask:0xf bank_mask:0xf
    s_nop 1
    v_add_f32_dpp v120, v120, v120 row_ror:1 row_mask:0xf bank_mask:0xf
    v_mul_f32 v120, 0x3acccccd, v120
    buffer_load_dword v118, v117, s[28:31], 0 offen sc1
    s_mov_b32 s62, 1966080
    buffer_load_dwordx4 v[52:55], v7, s[12:15], s62 offen
    s_mov_b32 s62, 0
    buffer_load_dwordx4 v[36:39], v7, s[12:15], s62 offen
    v_pk_add_f32 v[76:77], v[76:77], v[120:121] op_sel_hi:[1,0] neg_lo:[0,1] neg_hi:[0,1]
    v_pk_add_f32 v[78:79], v[78:79], v[120:121] op_sel_hi:[1,0] neg_lo:[0,1] neg_hi:[0,1]
    v_pk_add_f32 v[80:81], v[80:81], v[120:121] op_sel_hi:[1,0] neg_lo:[0,1] neg_hi:[0,1]
    v_pk_add_f32 v[82:83], v[82:83], v[120:121] op_sel_hi:[1,0] neg_lo:[0,1] neg_hi:[0,1]
    v_pk_add_f32 v[84:85], v[84:85], v[120:121] op_sel_hi:[1,0] neg_lo:[0,1] neg_hi:[0,1]
    v_pk_add_f32 v[86:87], v[86:87], v[120:121] op_sel_hi:[1,0] neg_lo:[0,1] neg_hi:[0,1]
    v_pk_add_f32 v[88:89], v[88:89], v[120:121] op_sel_hi:[1,0] neg_lo:[0,1] neg_hi:[0,1]
    v_pk_add_f32 v[90:91], v[90:91], v[120:121] op_sel_hi:[1,0] neg_lo:[0,1] neg_hi:[0,1]
    v_pk_add_f32 v[92:93], v[92:93], v[120:121] op_sel_hi:[1,0] neg_lo:[0,1] neg_hi:[0,1]
    v_pk_add_f32 v[94:95], v[94:95], v[120:121] op_sel_hi:[1,0] neg_lo:[0,1] neg_hi:[0,1]
    v_pk_add_f32 v[96:97], v[96:97], v[120:121] op_sel_hi:[1,0] neg_lo:[0,1] neg_hi:[0,1]
    v_pk_add_f32 v[98:99], v[98:99], v[120:121] op_sel_hi:[1,0] neg_lo:[0,1] neg_hi:[0,1]
    v_pk_add_f32 v[100:101], v[100:101], v[120:121] op_sel_hi:[1,0] neg_lo:[0,1] neg_hi:[0,1]
    v_pk_add_f32 v[102:103], v[102:103], v[120:121] op_sel_hi:[1,0] neg_lo:[0,1] neg_hi:[0,1]
    v_pk_add_f32 v[104:105], v[104:105], v[120:121] op_sel_hi:[1,0] neg_lo:[0,1] neg_hi:[0,1]
    v_pk_add_f32 v[106:107], v[106:107], v[120:121] op_sel_hi:[1,0] neg_lo:[0,1] neg_hi:[0,1]
    v_pk_add_f32 v[108:109], v[108:109], v[120:121] op_sel_hi:[1,0] neg_lo:[0,1] neg_hi:[0,1]
    v_pk_add_f32 v[110:111], v[110:111], v[120:121] op_sel_hi:[1,0] neg_lo:[0,1] neg_hi:[0,1]
    v_pk_add_f32 v[112:113], v[112:113], v[120:121] op_sel_hi:[1,0] neg_lo:[0,1] neg_hi:[0,1]
    v_pk_add_f32 v[114:115], v[114:115], v[120:121] op_sel_hi:[1,0] neg_lo:[0,1] neg_hi:[0,1]
    v_pk_mul_f32 v[122:123], v[76:77], v[76:77]
    v_pk_mul_f32 v[124:125], v[78:79], v[78:79]
    v_pk_fma_f32 v[122:123], v[80:81], v[80:81], v[122:123]
    v_pk_fma_f32 v[124:125], v[82:83], v[82:83], v[124:125]
    v_pk_fma_f32 v[122:123], v[84:85], v[84:85], v[122:123]
    v_pk_fma_f32 v[124:125], v[86:87], v[86:87], v[124:125]
    v_pk_fma_f32 v[122:123], v[88:89], v[88:89], v[122:123]
    v_pk_fma_f32 v[124:125], v[90:91], v[90:91], v[124:125]
    v_pk_fma_f32 v[122:123], v[92:93], v[92:93], v[122:123]
    v_pk_fma_f32 v[124:125], v[94:95], v[94:95], v[124:125]
    v_pk_fma_f32 v[122:123], v[96:97], v[96:97], v[122:123]
    v_pk_fma_f32 v[124:125], v[98:99], v[98:99], v[124:125]
    v_pk_fma_f32 v[122:123], v[100:101], v[100:101], v[122:123]
    v_pk_fma_f32 v[124:125], v[102:103], v[102:103], v[124:125]
    v_pk_fma_f32 v[122:123], v[104:105], v[104:105], v[122:123]
    v_pk_fma_f32 v[124:125], v[106:107], v[106:107], v[124:125]
    v_pk_fma_f32 v[122:123], v[108:109], v[108:109], v[122:123]
    v_pk_fma_f32 v[124:125], v[110:111], v[110:111], v[124:125]
    v_pk_fma_f32 v[122:123], v[112:113], v[112:113], v[122:123]
    v_pk_fma_f32 v[124:125], v[114:115], v[114:115], v[124:125]
    v_pk_add_f32 v[122:123], v[122:123], v[124:125]
    v_add_f32 v122, v122, v123
    s_nop 1
    v_add_f32_dpp v122, v122, v122 row_ror:8 row_mask:0xf bank_mask:0xf
    s_nop 1
    v_add_f32_dpp v122, v122, v122 row_ror:4 row_mask:0xf bank_mask:0xf
    s_nop 1
    v_add_f32_dpp v122, v122, v122 row_ror:2 row_mask:0xf bank_mask:0xf
    s_nop 1
    v_add_f32_dpp v122, v122, v122 row_ror:1 row_mask:0xf bank_mask:0xf
    v_mul_f32 v122, 0x3acccccd, v122
    v_cvt_pk_bf16_f32 v122, v122, v122
    v_and_b32 v122, 0xffff0000, v122
    v_add_f32 v122, 0x3727c5ac, v122
    v_cvt_pk_bf16_f32 v122, v122, v122
    v_and_b32 v122, 0xffff0000, v122
    v_sqrt_f32 v122, v122
    s_nop 0
    v_cvt_pk_bf16_f32 v126, v120, v122
    v_and_b32 v122, 0xffff0000, v126
    v_rcp_f32 v124, v122
    v_lshlrev_b32 v121, 16, v126
    v_sub_f32 v121, v120, v121
    v_mul_f32 v125, v121, v124
    v_mov_b32 v128, 0
    v_mov_b32 v129, 0
    v_pk_fma_f32 v[76:77], v[76:77], v[124:125], v[124:125] op_sel:[0,0,1] op_sel_hi:[1,0,1]
    v_pk_fma_f32 v[78:79], v[78:79], v[124:125], v[124:125] op_sel:[0,0,1] op_sel_hi:[1,0,1]
    v_pk_fma_f32 v[80:81], v[80:81], v[124:125], v[124:125] op_sel:[0,0,1] op_sel_hi:[1,0,1]
    v_pk_fma_f32 v[82:83], v[82:83], v[124:125], v[124:125] op_sel:[0,0,1] op_sel_hi:[1,0,1]
    v_pk_fma_f32 v[84:85], v[84:85], v[124:125], v[124:125] op_sel:[0,0,1] op_sel_hi:[1,0,1]
    v_pk_fma_f32 v[86:87], v[86:87], v[124:125], v[124:125] op_sel:[0,0,1] op_sel_hi:[1,0,1]
    v_pk_fma_f32 v[88:89], v[88:89], v[124:125], v[124:125] op_sel:[0,0,1] op_sel_hi:[1,0,1]
    v_pk_fma_f32 v[90:91], v[90:91], v[124:125], v[124:125] op_sel:[0,0,1] op_sel_hi:[1,0,1]
    v_pk_fma_f32 v[92:93], v[92:93], v[124:125], v[124:125] op_sel:[0,0,1] op_sel_hi:[1,0,1]
    v_pk_fma_f32 v[94:95], v[94:95], v[124:125], v[124:125] op_sel:[0,0,1] op_sel_hi:[1,0,1]
    v_pk_fma_f32 v[96:97], v[96:97], v[124:125], v[124:125] op_sel:[0,0,1] op_sel_hi:[1,0,1]
    v_pk_fma_f32 v[98:99], v[98:99], v[124:125], v[124:125] op_sel:[0,0,1] op_sel_hi:[1,0,1]
    v_pk_fma_f32 v[100:101], v[100:101], v[124:125], v[124:125] op_sel:[0,0,1] op_sel_hi:[1,0,1]
    v_pk_fma_f32 v[102:103], v[102:103], v[124:125], v[124:125] op_sel:[0,0,1] op_sel_hi:[1,0,1]
    v_pk_fma_f32 v[104:105], v[104:105], v[124:125], v[124:125] op_sel:[0,0,1] op_sel_hi:[1,0,1]
    v_pk_fma_f32 v[106:107], v[106:107], v[124:125], v[124:125] op_sel:[0,0,1] op_sel_hi:[1,0,1]
    v_pk_fma_f32 v[108:109], v[108:109], v[124:125], v[124:125] op_sel:[0,0,1] op_sel_hi:[1,0,1]
    v_pk_fma_f32 v[110:111], v[110:111], v[124:125], v[124:125] op_sel:[0,0,1] op_sel_hi:[1,0,1]
    v_pk_fma_f32 v[112:113], v[112:113], v[124:125], v[124:125] op_sel:[0,0,1] op_sel_hi:[1,0,1]
    v_pk_fma_f32 v[114:115], v[114:115], v[124:125], v[124:125] op_sel:[0,0,1] op_sel_hi:[1,0,1]
    v_cvt_pk_bf16_f32 v16, v76, v77
    v_cvt_pk_bf16_f32 v17, v78, v79
    v_cvt_pk_bf16_f32 v18, v80, v81
    v_cvt_pk_bf16_f32 v19, v82, v83
    v_cvt_pk_bf16_f32 v20, v84, v85
    v_cvt_pk_bf16_f32 v21, v86, v87
    v_cvt_pk_bf16_f32 v22, v88, v89
    v_cvt_pk_bf16_f32 v23, v90, v91
    v_cvt_pk_bf16_f32 v24, v92, v93
    v_cvt_pk_bf16_f32 v25, v94, v95
    v_cvt_pk_bf16_f32 v26, v96, v97
    v_cvt_pk_bf16_f32 v27, v98, v99
    v_cvt_pk_bf16_f32 v28, v100, v101
    v_cvt_pk_bf16_f32 v29, v102, v103
    v_cvt_pk_bf16_f32 v30, v104, v105
    v_cvt_pk_bf16_f32 v31, v106, v107
    v_cvt_pk_bf16_f32 v32, v108, v109
    v_cvt_pk_bf16_f32 v33, v110, v111
    v_cvt_pk_bf16_f32 v34, v112, v113
    v_cvt_pk_bf16_f32 v35, v114, v115
    s_waitcnt vmcnt(7)
    v_dot2c_f32_bf16 v128, v16, v56
    v_dot2c_f32_bf16 v129, v17, v57
    v_dot2c_f32_bf16 v128, v18, v58
    v_dot2c_f32_bf16 v129, v19, v59
    v_dot2c_f32_bf16 v128, v20, v60
    v_dot2c_f32_bf16 v129, v21, v61
    v_dot2c_f32_bf16 v128, v22, v62
    v_dot2c_f32_bf16 v129, v23, v63
    v_dot2c_f32_bf16 v128, v24, v64
    v_dot2c_f32_bf16 v129, v25, v65
    v_dot2c_f32_bf16 v128, v26, v66
    v_dot2c_f32_bf16 v129, v27, v67
    v_dot2c_f32_bf16 v128, v28, v68
    v_dot2c_f32_bf16 v129, v29, v69
    v_dot2c_f32_bf16 v128, v30, v70
    v_dot2c_f32_bf16 v129, v31, v71
    v_dot2c_f32_bf16 v128, v32, v72
    v_dot2c_f32_bf16 v129, v33, v73
    v_dot2c_f32_bf16 v128, v34, v74
    v_dot2c_f32_bf16 v129, v35, v75
    s_nop 2
    v_add_f32 v128, v128, v129
    s_nop 1
    v_add_f32_dpp v128, v128, v128 row_ror:8 row_mask:0xf bank_mask:0xf
    s_nop 1
    v_add_f32_dpp v128, v128, v128 row_ror:4 row_mask:0xf bank_mask:0xf
    s_nop 1
    v_add_f32_dpp v128, v128, v128 row_ror:2 row_mask:0xf bank_mask:0xf
    s_nop 1
    v_add_f32_dpp v128, v128, v128 row_ror:1 row_mask:0xf bank_mask:0xf
    v_cvt_pk_bf16_f32 v128, v128, v128
    v_ashrrev_i32 v129, 31, v128
    v_or_b32 v129, 0x80000000, v129
    v_xor_b32 v128, v128, v129
    v_and_b32 v128, 0xffff0000, v128
    v_sub_u32 v129, 2047, v5
    v_or_b32 v127, v128, v129
    s_lshl_b32 s3, s4, 5
    s_add_u32 s3, s3, 158976
    v_lshl_add_u32 v129, v3, 3, s3
    ds_write_b64 v129, v[126:127]
    v_mov_b32 v1, 153472
    v_mov_b64 v[120:121], 0
    ds_write_b64 v1, v[120:121] offset:16
    ds_write_b32 v1, v120 offset:24
    s_waitcnt vmcnt(2) lgkmcnt(0)
    s_mov_b32 s3, 0
L_rp_61:
    v_cmp_eq_u32 vcc, 0, v118
    s_cbranch_vccz L_rdone_62
    s_add_u32 s3, s3, 1
    s_cmp_gt_u32 s3, 200000
    s_cbranch_scc1 L_rdone_62
    s_sleep 8
    buffer_load_dword v118, v117, s[28:31], 0 offen sc1
    s_waitcnt vmcnt(0)
    s_branch L_rp_61
L_rdone_62:
    s_barrier
    s_cmp_eq_u32 s4, 7
    s_cbranch_scc0 L_h2
    s_setprio 1
    v_and_b32 v129, 31, v0
    v_lshlrev_b32 v128, 3, v129
    v_add_u32 v128, 158976, v128
    ds_read_b64 v[126:127], v128
    s_lshl_b32 s63, s55, 7
    s_add_u32 s62, s63, 8192
    s_add_u32 s66, s63, 32768
    v_lshlrev_b32 v129, 2, v129
    v_mov_b32 v125, 0
    s_getreg_b32 s3, hwreg(HW_REG_XCC_ID)
    v_mov_b32 v124, s3
    s_waitcnt lgkmcnt(0)
    buffer_store_dword v126, v129, s[16:19], s62 offen sc1
    v_max_u32_dpp v128, v127, v127 row_ror:8 row_mask:0xf bank_mask:0xf
    s_nop 1
    v_max_u32_dpp v128, v128, v128 row_ror:4 row_mask:0xf bank_mask:0xf
    s_nop 1
    v_max_u32_dpp v128, v128, v128 row_ror:2 row_mask:0xf bank_mask:0xf
    s_nop 1
    v_max_u32_dpp v128, v128, v128 row_ror:1 row_mask:0xf bank_mask:0xf
    s_nop 1
    v_max_u32_dpp v128, v128, v128 row_bcast:15 row_mask:0xa bank_mask:0xf
    s_nop 1
    v_max_u32_dpp v128, v128, v128 row_bcast:31 row_mask:0xc bank_mask:0xf
    s_nop 0
    v_readlane_b32 s62, v128, 63
    s_nop 1
    v_cmp_eq_u32 vcc, s62, v127
    s_nop 1
    v_cndmask_b32 v127, v127, v125, vcc
    s_nop 1
    v_max_u32_dpp v128, v127, v127 row_ror:8 row_mask:0xf bank_mask:0xf
    s_nop 1
    v_max_u32_dpp v128, v128, v128 row_ror:4 row_mask:0xf bank_mask:0xf
    s_nop 1
    v_max_u32_dpp v128, v128, v128 row_ror:2 row_mask:0xf bank_mask:0xf
    s_nop 1
    v_max_u32_dpp v128, v128, v128 row_ror:1 row_mask:0xf bank_mask:0xf
    s_nop 1
    v_max_u32_dpp v128, v128, v128 row_bcast:15 row_mask:0xa bank_mask:0xf
    s_nop 1
    v_max_u32_dpp v128, v128, v128 row_bcast:31 row_mask:0xc bank_mask:0xf
    s_nop 0
    v_readlane_b32 s63, v128, 63
    v_mov_b32 v122, s62
    s_nop 0
    v_mov_b32 v123, s63
    s_mov_b64 exec, 1
    buffer_store_dwordx3 v[122:124], off, s[16:19], s66 sc1
    s_mov_b64 exec, -1
    s_and_b32 s3, s55, 3
    s_lshl_b32 s3, s3, 10
    v_lshlrev_b32 v126, 7, v0
    v_mov_b32 v127, 1
    s_mov_b64 exec, 0xff
    buffer_atomic_add v127, v126, s[16:19], s3 offen sc1
    s_mov_b64 exec, -1
    s_waitcnt vmcnt(3)
    s_branch L_h2a
L_h2:
    s_waitcnt vmcnt(0)
L_h2a:
    s_mov_b32 exec_hi, s67
    s_mov_b32 m0, s69
    s_add_u32 s69, s69, s71
    buffer_load_dwordx4 v130, s[40:43], s68 offen nt lds
    s_add_u32 s68, s68, s70
    s_mov_b32 m0, s69
    s_add_u32 s69, s69, s71
    buffer_load_dwordx4 v130, s[40:43], s68 offen nt lds
    s_add_u32 s68, s68, s70
    s_mov_b32 m0, s69
    s_add_u32 s69, s69, s71
    buffer_load_dwordx4 v130, s[40:43], s68 offen nt lds
    s_add_u32 s68, s68, s70
    s_mov_b32 m0, s69
    s_add_u32 s69, s69, s71
    buffer_load_dwordx4 v130, s[40:43], s68 offen nt lds
    s_add_u32 s68, s68, s70
    s_mov_b32 exec_hi, -1
    s_mov_b32 s62, 0x00003f80
    s_mov_b32 s63, 0x3f800000
    v_mov_b64 v[76:77], 0
    v_mov_b64 v[78:79], 0
    v_mov_b64 v[80:81], 0
    v_mov_b64 v[82:83], 0
    v_dot2c_f32_bf16 v76, s62, v36
    v_dot2c_f32_bf16 v77, s63, v36
    v_dot2c_f32_bf16 v78, s62, v37
    v_dot2c_f32_bf16 v79, s63, v37
    v_dot2c_f32_bf16 v80, s62, v38
    v_dot2c_f32_bf16 v81, s63, v38
    v_dot2c_f32_bf16 v82, s62, v39
    v_dot2c_f32_bf16 v83, s63, v39
    v_dot2c_f32_bf16 v76, s62, v40
    v_dot2c_f32_bf16 v77, s63, v40
    v_dot2c_f32_bf16 v78, s62, v41
    v_dot2c_f32_bf16 v79, s63, v41
    v_dot2c_f32_bf16 v80, s62, v42
    v_dot2c_f32_bf16 v81, s63, v42
    v_dot2c_f32_bf16 v82, s62, v43
    v_dot2c_f32_bf16 v83, s63, v43
    v_dot2c_f32_bf16 v76, s62, v44
    v_dot2c_f32_bf16 v77, s63, v44
    v_dot2c_f32_bf16 v78, s62, v45
    v_dot2c_f32_bf16 v79, s63, v45
    v_dot2c_f32_bf16 v80, s62, v46
    v_dot2c_f32_bf16 v81, s63, v46
    v_dot2c_f32_bf16 v82, s62, v47
    v_dot2c_f32_bf16 v83, s63, v47
    v_dot2c_f32_bf16 v76, s62, v48
    v_dot2c_f32_bf16 v77, s63, v48
    v_dot2c_f32_bf16 v78, s62, v49
    v_dot2c_f32_bf16 v79, s63, v49
    v_dot2c_f32_bf16 v80, s62, v50
    v_dot2c_f32_bf16 v81, s63, v50
    v_dot2c_f32_bf16 v82, s62, v51
    v_dot2c_f32_bf16 v83, s63, v51
    v_dot2c_f32_bf16 v76, s62, v52
    v_dot2c_f32_bf16 v77, s63, v52
    v_dot2c_f32_bf16 v78, s62, v53
    v_dot2c_f32_bf16 v79, s63, v53
    v_dot2c_f32_bf16 v80, s62, v54
    v_dot2c_f32_bf16 v81, s63, v54
    v_dot2c_f32_bf16 v82, s62, v55
    v_dot2c_f32_bf16 v83, s63, v55
    v_permlane32_swap_b32 v76, v80
    v_permlane32_swap_b32 v77, v81
    v_permlane32_swap_b32 v78, v82
    v_permlane32_swap_b32 v79, v83
    v_pk_add_f32 v[76:77], v[76:77], v[80:81]
    v_pk_add_f32 v[78:79], v[78:79], v[82:83]
    s_nop 1
    v_permlane16_swap_b32 v76, v78
    v_permlane16_swap_b32 v77, v79
    v_pk_add_f32 v[76:77], v[76:77], v[78:79]
    s_nop 1
    v_add_f32_dpp v76, v76, v76 row_ror:8 row_mask:0xf bank_mask:0xf
    v_add_f32_dpp v77, v77, v77 row_ror:8 row_mask:0xf bank_mask:0xf
    s_lshl_b32 s3, s4, 8
    s_add_u32 s3, s3, 159232
    v_lshl_add_u32 v129, v8, 5, s3
    v_lshl_add_u32 v129, v3, 3, v129
    ds_write_b64 v129, v[76:77]
    v_mov_b32 v39, v1
    s_waitcnt lgkmcnt(0)
    s_barrier
    s_cmp_eq_u32 s4, 0
    s_cbranch_scc0 L_h3
    v_lshlrev_b32 v119, 2, v0
    v_add_u32 v128, 159232, v119
    ds_read_b32 v76, v128 offset:0
    ds_read_b32 v77, v128 offset:256
    ds_read_b32 v78, v128 offset:512
    ds_read_b32 v79, v128 offset:768
    ds_read_b32 v80, v128 offset:1024
    ds_read_b32 v81, v128 offset:1280
    ds_read_b32 v82, v128 offset:1536
    ds_read_b32 v83, v128 offset:1792
    s_lshl_b32 s63, s61, 1
    s_mul_i32 s3, s59, 7680
    s_add_u32 s63, s63, s3
    s_add_u32 s63, s63, 16384
    s_cmp_eq_u32 s60, 15
    s_cselect_b32 s63, 0x7ff00000, s63
    s_waitcnt lgkmcnt(0)
    v_pk_add_f32 v[76:77], v[76:77], v[78:79]
    v_pk_add_f32 v[80:81], v[80:81], v[82:83]
    v_pk_add_f32 v[76:77], v[76:77], v[80:81]
    v_add_f32 v76, v76, v77
    v_and_b32 v77, 0xffff0000, v76
    v_sub_f32 v76, v76, v77
    v_cvt_pk_bf16_f32 v76, v77, v76
    buffer_store_dword v76, v119, s[16:19], s63 offen sc1
L_h3:
    s_barrier
    s_cmp_eq_u32 s4, 7
    s_cbranch_scc1 L_hroute
    s_mov_b32 exec_hi, s67
    s_mov_b32 m0, s69
    s_add_u32 s69, s69, s71
    buffer_load_dwordx4 v130, s[40:43], s68 offen nt lds
    s_add_u32 s68, s68, s70
    s_mov_b32 m0, s69
    s_add_u32 s69, s69, s71
    buffer_load_dwordx4 v130, s[40:43], s68 offen nt lds
    s_add_u32 s68, s68, s70
    s_mov_b32 m0, s69
    s_add_u32 s69, s69, s71
    buffer_load_dwordx4 v130, s[40:43], s68 offen nt lds
    s_add_u32 s68, s68, s70
    s_mov_b32 m0, s69
    s_add_u32 s69, s69, s71
    buffer_load_dwordx4 v130, s[40:43], s68 offen nt lds
    s_add_u32 s68, s68, s70
    s_mov_b32 m0, s69
    s_add_u32 s69, s69, s71
    buffer_load_dwordx4 v130, s[40:43], s68 offen nt lds
    s_add_u32 s68, s68, s70
    s_mov_b32 m0, s69
    s_add_u32 s69, s69, s71
    buffer_load_dwordx4 v130, s[40:43], s68 offen nt lds
    s_add_u32 s68, s68, s70
    s_mov_b32 exec_hi, -1
    s_cmp_eq_u32 s4, 6
    s_cbranch_scc0 L_h4
    s_mov_b32 s53, 0
L_h4a:
    s_mov_b32 exec_hi, s67
    s_mov_b32 m0, s69
    s_add_u32 s69, s69, s71
    buffer_load_dwordx4 v130, s[40:43], s68 offen nt lds
    s_add_u32 s68, s68, s70
    s_mov_b32 exec_hi, -1
    s_add_u32 s53, s53, 1
    s_cmp_lt_u32 s53, 18
    s_cbranch_scc1 L_h4a
L_h4:
    s_mul_i32 s66, s56, 5120
    s_add_u32 s66, s66, 4259840
    s_add_u32 s63, s66, 4096
    buffer_store_dwordx4 v[12:15], v2, s[16:19], s66 offen offset:0 sc1
    buffer_store_dwordx4 v[12:15], v2, s[16:19], s66 offen offset:1024 sc1
    buffer_store_dwordx4 v[12:15], v2, s[16:19], s66 offen offset:2048 sc1
    buffer_store_dwordx4 v[12:15], v2, s[16:19], s66 offen offset:3072 sc1
    buffer_store_dwordx4 v[12:15], v2, s[16:19], s63 offen offset:0 sc1
    s_or_b32 s3, s56, 7
    s_mul_i32 s3, s3, 5120
    s_lshl_b32 s53, s4, 10
    s_add_u32 s3, s3, s53
    s_add_u32 s3, s3, 4259840
    s_cmp_lt_u32 s4, 5
    s_cselect_b32 s3, s3, 0x7ff00000
    buffer_store_dwordx4 v[12:15], v2, s[16:19], s3 offen sc1
    v_lshrrev_b32 v5, 5, v0
    v_bfe_u32 v4, v0, 2, 2
    v_lshl_add_u32 v6, v5, 3, v4
    v_and_b32 v11, 1, v0
    v_bfe_u32 v9, v0, 4, 1
    v_and_b32 v131, 3, v0
    v_lshl_add_u32 v131, v9, 2, v131
    v_lshlrev_b32 v131, 3, v131
    v_and_b32 v26, 31, v0
    v_lshlrev_b32 v36, 2, v26
    s_movk_i32 s3, 768
    v_mad_u32_u24 v36, v5, s3, v36
    s_mul_i32 s62, s55, 3072
    s_lshl_b32 s3, s64, 9
    s_add_u32 s62, s62, s3
    s_lshl_b32 s3, s65, 8
    s_add_u32 s62, s62, s3
    s_add_u32 s62, s62, 2686976
    s_mov_b32 s60, 0
    v_mul_u32_u24 v98, 6554, v0
    v_lshlrev_b32 v97, 4, v0
    s_movk_i32 s3, 1120
    v_lshrrev_b32 v96, 16, v98
    v_mad_u32_u24 v224, v96, s3, v97
    v_add_u32 v98, 419456, v98
    v_lshrrev_b32 v96, 16, v98
    v_mad_u32_u24 v225, v96, s3, v97
    v_add_u32 v98, 419456, v98
    v_lshrrev_b32 v96, 16, v98
    v_mad_u32_u24 v226, v96, s3, v97
    v_add_u32 v98, 419456, v98
    v_lshrrev_b32 v96, 16, v98
    v_mad_u32_u24 v227, v96, s3, v97
    v_add_u32 v98, 419456, v98
    v_lshrrev_b32 v96, 16, v98
    v_mad_u32_u24 v228, v96, s3, v97
    v_add_u32 v228, 4096, v228
    s_and_b32 s67, s6, 7
    s_mul_i32 s67, s67, 160
    s_mul_i32 s68, s60, 40960
    s_add_u32 s68, s68, s67
    s_mul_i32 s69, s60, 5120
    s_lshr_b32 s3, s6, 3
    s_lshl2_add_u32 s3, s5, s3
    s_mul_i32 s67, s3, 81920
    s_add_u32 s67, s67, s68
    s_bfe_u32 s3, s6, 0x10003
    s_mul_i32 s98, s3, 163840
    s_add_u32 s96, s68, s98
    s_sub_u32 s98, s68, s98
    s_mul_i32 s99, s3, 20480
    s_add_u32 s97, s69, s99
    s_sub_u32 s99, s69, s99
    v_mul_u32_u24 v10, 160, v11
    v_lshl_add_u32 v10, v5, 4, v10
    v_add_u32 v10, 152960, v10
    v_cmp_gt_u32 vcc, 32, v0
    s_cmp_lt_u32 s4, 6
    s_cbranch_scc0 L_h5a
    s_mul_i32 s3, s4, 10240
    v_lshl_add_u32 v9, v6, 7, v131
    v_add_u32 v9, s3, v9
    s_waitcnt vmcnt(6)
    ds_read_b64_tr_b16 v[132:133], v9 offset:0
    ds_read_b64_tr_b16 v[134:135], v9 offset:512
    ds_read_b64_tr_b16 v[136:137], v9 offset:64
    ds_read_b64_tr_b16 v[138:139], v9 offset:576
    ds_read_b64_tr_b16 v[140:141], v9 offset:2048
    ds_read_b64_tr_b16 v[142:143], v9 offset:2560
    ds_read_b64_tr_b16 v[144:145], v9 offset:2112
    ds_read_b64_tr_b16 v[146:147], v9 offset:2624
    ds_read_b64_tr_b16 v[148:149], v9 offset:4096
    ds_read_b64_tr_b16 v[150:151], v9 offset:4608
    ds_read_b64_tr_b16 v[152:153], v9 offset:4160
    ds_read_b64_tr_b16 v[154:155], v9 offset:4672
    ds_read_b64_tr_b16 v[156:157], v9 offset:6144
    ds_read_b64_tr_b16 v[158:159], v9 offset:6656
    ds_read_b64_tr_b16 v[160:161], v9 offset:6208
    ds_read_b64_tr_b16 v[162:163], v9 offset:6720
    ds_read_b64_tr_b16 v[164:165], v9 offset:8192
    ds_read_b64_tr_b16 v[166:167], v9 offset:8704
    ds_read_b64_tr_b16 v[168:169], v9 offset:8256
    ds_read_b64_tr_b16 v[170:171], v9 offset:8768
L_h5a:
    s_waitcnt vmcnt(0) lgkmcnt(0)
    v_mov_b32 v9, 1
    s_mov_b64 exec, 1
    ds_add_u32 v39, v9 offset:24
    s_mov_b64 exec, -1
    s_cmp_eq_u32 s4, 6
    s_cbranch_scc1 L_hbulk
    v_and_b32 v9, 15, v0
    v_lshlrev_b32 v37, 3, v9
    v_mul_u32_u24 v38, 768, v3
    v_add_u32 v37, v37, v38
    v_bfe_u32 v38, v0, 4, 1
    v_mul_u32_u24 v38, 384, v38
    v_lshl_add_u32 v38, v9, 2, v38
    v_lshl_add_u32 v38, v5, 1, v38
    s_lshl_b32 s3, s4, 6
    s_add_u32 s3, s3, 155008
    v_add_u32 v38, s3, v38
    s_mul_i32 s66, s5, 24576
    s_lshl_b32 s3, s4, 7
    s_add_u32 s66, s66, s3
    s_add_u32 s66, s66, 2686976
    buffer_load_dword v76, v36, s[16:19], s62 offen offset:0 sc1
    buffer_load_dword v77, v36, s[16:19], s62 offen offset:128 sc1
    s_mov_b32 s53, 0
L_lp_63:
    ds_read_b32 v9, v39 offset:16
    s_add_u32 s53, s53, 1
    s_cmp_gt_u32 s53, 12800000
    s_cbranch_scc1 L_lo_64
    s_waitcnt lgkmcnt(0)
    v_readfirstlane_b32 s3, v9
    s_nop 0
    s_cmp_lt_u32 s3, 1
    s_cbranch_scc1 L_lp_63
L_lo_64:
    ds_read_b96 v[122:124], v39
    ds_read_b128 v[16:19], v10 offset:0
    ds_read_b128 v[20:23], v10 offset:32
    ds_read_b128 v[24:27], v10 offset:64
    ds_read_b128 v[28:31], v10 offset:96
    ds_read_b128 v[32:35], v10 offset:128
    s_waitcnt lgkmcnt(4)
    v_mfma_f32_32x32x16_bf16 v[176:191], v[16:19], v[132:135], 0
    v_mfma_f32_32x32x16_bf16 v[192:207], v[16:19], v[136:139], 0
    s_waitcnt lgkmcnt(3)
    v_mfma_f32_32x32x16_bf16 v[176:191], v[20:23], v[140:143], v[176:191]
    v_mfma_f32_32x32x16_bf16 v[192:207], v[20:23], v[144:147], v[192:207]
    s_waitcnt lgkmcnt(2)
    v_mfma_f32_32x32x16_bf16 v[176:191], v[24:27], v[148:151], v[176:191]
    v_mfma_f32_32x32x16_bf16 v[192:207], v[24:27], v[152:155], v[192:207]
    s_waitcnt lgkmcnt(1)
    v_mfma_f32_32x32x16_bf16 v[176:191], v[28:31], v[156:159], v[176:191]
    v_mfma_f32_32x32x16_bf16 v[192:207], v[28:31], v[160:163], v[192:207]
    s_waitcnt lgkmcnt(0)
    v_mfma_f32_32x32x16_bf16 v[176:191], v[32:35], v[164:167], v[176:191]
    v_mfma_f32_32x32x16_bf16 v[192:207], v[32:35], v[168:171], v[192:207]
    v_readfirstlane_b32 s53, v124
    s_nop 9
    v_cndmask_b32 v120, v177, v176, vcc
    v_cndmask_b32 v121, v193, v192, vcc
    s_cmp_eq_u32 s53, 0
    s_cbranch_scc1 L_h7
    buffer_store_dword v120, v36, s[16:19], s62 offen offset:0 sc1
    buffer_store_dword v121, v36, s[16:19], s62 offen offset:128 sc1
    s_branch L_h8
L_h7:
    buffer_store_dword v120, v36, s[16:19], s62 offen offset:0
    buffer_store_dword v121, v36, s[16:19], s62 offen offset:128
L_h8:
    s_waitcnt vmcnt(0)
    s_mov_b32 s3, 0
L_poll_65:
    s_add_u32 s3, s3, 1
    s_cmp_gt_u32 s3, 200000
    s_cbranch_scc1 L_pdone_67
    s_mov_b32 s63, s66
    buffer_load_dwordx2 v[76:77], v37, s[16:19], s63 offen offset:0 sc1
    buffer_load_dwordx2 v[78:79], v37, s[16:19], s63 offen offset:3072 sc1
    s_add_u32 s63, s63, 6144
    buffer_load_dwordx2 v[80:81], v37, s[16:19], s63 offen offset:0 sc1
    buffer_load_dwordx2 v[82:83], v37, s[16:19], s63 offen offset:3072 sc1
    s_add_u32 s63, s63, 6144
    buffer_load_dwordx2 v[84:85], v37, s[16:19], s63 offen offset:0 sc1
    buffer_load_dwordx2 v[86:87], v37, s[16:19], s63 offen offset:3072 sc1
    s_add_u32 s63, s63, 6144
    buffer_load_dwordx2 v[88:89], v37, s[16:19], s63 offen offset:0 sc1
    buffer_load_dwordx2 v[90:91], v37, s[16:19], s63 offen offset:3072 sc1
L_chk_66:
    s_waitcnt vmcnt(0)
    v_max3_u32 v10, v76, v77, v78
    v_max3_u32 v10, v10, v79, v80
    v_max3_u32 v10, v10, v81, v82
    v_max3_u32 v10, v10, v83, v84
    v_max3_u32 v10, v10, v85, v86
    v_max3_u32 v10, v10, v87, v88
    v_max3_u32 v10, v10, v89, v90
    v_max_u32 v10, v10, v91
    v_cmp_eq_u32 vcc, s52, v10
    s_cbranch_vccnz L_poll_65
L_pdone_67:
    v_pk_add_f32 v[76:77], v[76:77], v[84:85]
    v_pk_add_f32 v[78:79], v[78:79], v[86:87]
    v_pk_add_f32 v[80:81], v[80:81], v[88:89]
    v_pk_add_f32 v[82:83], v[82:83], v[90:91]
    v_pk_add_f32 v[76:77], v[76:77], v[80:81]
    v_pk_add_f32 v[78:79], v[78:79], v[82:83]
    v_pk_add_f32 v[76:77], v[76:77], v[78:79]
    s_nop 1
    v_permlane32_swap_b32 v76, v77
    v_cvt_pk_bf16_f32 v120, v76, v77
    v_lshlrev_b32 v121, 16, v120
    v_and_b32 v120, 0xffff0000, v120
    v_mul_f32 v119, 0xbfb8aa3b, v121
    v_exp_f32 v119, v119
    s_nop 0
    v_add_f32 v119, 1.0, v119
    v_rcp_f32 v119, v119
    s_nop 0
    v_mul_f32 v121, v121, v119
    v_cvt_pk_bf16_f32 v121, v121, v121
    v_and_b32 v121, 0xffff0000, v121
    v_mul_f32 v121, v121, v120
    v_cvt_pk_bf16_f32 v121, v121, v121
    ds_write_b16 v38, v121
    v_mov_b32 v9, 1
    s_mov_b64 exec, 1
    ds_add_u32 v39, v9 offset:20
    s_mov_b64 exec, -1
    s_cmp_lt_u32 s4, 5
    s_cbranch_scc0 L_h13
    s_mov_b32 s53, 0
L_lp_68:
    ds_read_b32 v9, v39 offset:24
    s_add_u32 s53, s53, 1
    s_cmp_gt_u32 s53, 12800000
    s_cbranch_scc1 L_lo_69
    s_waitcnt lgkmcnt(0)
    v_readfirstlane_b32 s3, v9
    s_nop 0
    s_cmp_lt_u32 s3, 7
    s_cbranch_scc1 L_lp_68
L_lo_69:
    v_lshl_add_u32 v8, v3, 3, v4
    v_mul_u32_u24 v8, 160, v8
    v_and_b32 v10, 3, v0
    v_lshl_add_u32 v8, v10, 3, v8
    s_lshl_b32 s3, s4, 5
    s_add_u32 s3, s3, 112640
    v_add_u32 v8, s3, v8
    ds_read_b64_tr_b16 v[132:133], v8 offset:0
    ds_read_b64_tr_b16 v[134:135], v8 offset:640
    ds_read_b64_tr_b16 v[136:137], v8 offset:5120
    ds_read_b64_tr_b16 v[138:139], v8 offset:5760
    ds_read_b64_tr_b16 v[140:141], v8 offset:10240
    ds_read_b64_tr_b16 v[142:143], v8 offset:10880
    ds_read_b64_tr_b16 v[144:145], v8 offset:15360
    ds_read_b64_tr_b16 v[146:147], v8 offset:16000
    ds_read_b64_tr_b16 v[148:149], v8 offset:20480
    ds_read_b64_tr_b16 v[150:151], v8 offset:21120
    ds_read_b64_tr_b16 v[152:153], v8 offset:25600
    ds_read_b64_tr_b16 v[154:155], v8 offset:26240
    v_mul_u32_u24 v10, 384, v11
    v_lshl_add_u32 v10, v3, 4, v10
    v_add_u32 v10, 155008, v10
    s_mov_b32 s53, 0
L_lp_70:
    ds_read_b32 v9, v39 offset:20
    s_add_u32 s53, s53, 1
    s_cmp_gt_u32 s53, 12800000
    s_cbranch_scc1 L_lo_71
    s_waitcnt lgkmcnt(0)
    v_readfirstlane_b32 s3, v9
    s_nop 0
    s_cmp_lt_u32 s3, 6
    s_cbranch_scc1 L_lp_70
L_lo_71:
    ds_read_b128 v[40:43], v10 offset:0
    ds_read_b128 v[44:47], v10 offset:64
    ds_read_b128 v[48:51], v10 offset:128
    ds_read_b128 v[52:55], v10 offset:192
    ds_read_b128 v[56:59], v10 offset:256
    ds_read_b128 v[60:63], v10 offset:320
    v_and_b32 v9, 3, v0
    v_lshlrev_b32 v9, 2, v9
    v_lshl_add_u32 v9, v4, 7, v9
    s_movk_i32 s3, 20480
    v_mad_u32_u24 v9, v3, s3, v9
    v_cmp_gt_u32 vcc, 16, v0
    s_lshl_b32 s62, s5, 4
    s_mul_i32 s3, s54, 2560
    s_add_u32 s62, s62, s3
    s_lshl_b32 s3, s4, 9
    s_add_u32 s62, s62, s3
    s_add_u32 s62, s62, 2883584
    s_waitcnt lgkmcnt(0)
    v_mfma_f32_16x16x32_bf16 v[176:179], v[40:43], v[132:135], 0
    v_mfma_f32_16x16x32_bf16 v[176:179], v[44:47], v[136:139], v[176:179]
    v_mfma_f32_16x16x32_bf16 v[176:179], v[48:51], v[140:143], v[176:179]
    v_mfma_f32_16x16x32_bf16 v[176:179], v[52:55], v[144:147], v[176:179]
    v_mfma_f32_16x16x32_bf16 v[176:179], v[56:59], v[148:151], v[176:179]
    v_mfma_f32_16x16x32_bf16 v[176:179], v[60:63], v[152:155], v[176:179]
    s_nop 7
    v_cndmask_b32 v120, v177, v176, vcc
    s_mov_b32 exec_hi, 0
    buffer_store_dword v120, v9, s[16:19], s62 offen sc1
    s_mov_b32 exec_hi, -1
    s_branch L_h13
L_hroute:
    s_lshl_b32 s53, s5, 7
    v_lshlrev_b32 v124, 10, v0
    s_mov_b64 exec, 0xf
    s_mov_b32 s3, 0
L_cp_72:
    v_mov_b32 v125, 0
    s_add_u32 s3, s3, 1
    s_cmp_gt_u32 s3, 200000
    s_cbranch_scc1 L_cdone_73
    buffer_atomic_or v125, v124, s[16:19], s53 offen sc0 sc1
    s_waitcnt vmcnt(0)
    v_cmp_ne_u32 vcc, 0xff81ff91, v125
    s_cbranch_vccnz L_cp_72
L_cdone_73:
    s_mov_b64 exec, -1
    v_lshlrev_b32 v126, 7, v0
    v_add_u32 v126, 32768, v126
    s_mov_b32 s3, 0
L_poll_74:
    s_add_u32 s3, s3, 1
    s_cmp_gt_u32 s3, 200000
    s_cbranch_scc1 L_pdone_76
    buffer_load_dwordx3 v[122:124], v126, s[16:19], 0 offen sc1
L_chk_75:
    s_waitcnt vmcnt(0)
    v_max3_u32 v125, v122, v123, v124
    v_cmp_eq_u32 vcc, s52, v125
    s_cbranch_vccnz L_poll_74
L_pdone_76:
    s_getreg_b32 s3, hwreg(HW_REG_XCC_ID)
    v_cmp_ne_u32 vcc, s3, v124
    s_lshl_b32 s3, s5, 3
    s_lshr_b64 s[62:63], vcc, s3
    s_and_b32 s62, s62, 0xff
    v_max_u32_dpp v125, v122, v122 row_ror:8 row_mask:0xf bank_mask:0xf
    s_nop 1
    v_max_u32_dpp v125, v125, v125 row_ror:4 row_mask:0xf bank_mask:0xf
    s_nop 1
    v_max_u32_dpp v125, v125, v125 row_ror:2 row_mask:0xf bank_mask:0xf
    s_nop 1
    v_max_u32_dpp v125, v125, v125 row_ror:1 row_mask:0xf bank_mask:0xf
    s_nop 1
    v_max_u32_dpp v125, v125, v125 row_bcast:15 row_mask:0xa bank_mask:0xf
    s_nop 1
    v_max_u32_dpp v125, v125, v125 row_bcast:31 row_mask:0xc bank_mask:0xf
    s_nop 0
    v_readlane_b32 s100, v125, 63
    s_nop 1
    v_cmp_eq_u32 vcc, s100, v122
    s_nop 1
    v_cndmask_b32 v122, v122, v123, vcc
    s_nop 1
    v_max_u32_dpp v125, v122, v122 row_ror:8 row_mask:0xf bank_mask:0xf
    s_nop 1
    v_max_u32_dpp v125, v125, v125 row_ror:4 row_mask:0xf bank_mask:0xf
    s_nop 1
    v_max_u32_dpp v125, v125, v125 row_ror:2 row_mask:0xf bank_mask:0xf
    s_nop 1
    v_max_u32_dpp v125, v125, v125 row_ror:1 row_mask:0xf bank_mask:0xf
    s_nop 1
    v_max_u32_dpp v125, v125, v125 row_bcast:15 row_mask:0xa bank_mask:0xf
    s_nop 1
    v_max_u32_dpp v125, v125, v125 row_bcast:31 row_mask:0xc bank_mask:0xf
    s_nop 0
    v_readlane_b32 s101, v125, 63
    v_mov_b32 v122, s100
    s_nop 0
    v_mov_b32 v123, s101
    v_mov_b32 v124, s62
    ds_write_b96 v39, v[122:124]
    s_cmp_eq_u32 s55, 0
    s_mov_b32 s3, 6144
    s_cselect_b32 s3, s3, 0x7ff00000
    s_mov_b64 exec, 1
    buffer_store_dwordx2 v[122:123], off, s[16:19], s3 sc1
    s_mov_b64 exec, 0xfffff
    v_cmp_lt_u32 vcc, 9, v0
    s_nop 1
    v_cndmask_b32 v9, v122, v123, vcc
    v_and_b32 v9, 0x7ff, v9
    v_sub_u32 v9, 2047, v9
    v_lshlrev_b32 v10, 2, v9
    v_add_u32 v10, 8192, v10
    v_mul_u32_u24 v9, 1280, v9
    v_add_u32 v9, v9, v2
    v_subrev_u32 v11, 160, v9
    v_cndmask_b32 v9, v9, v11, vcc
    s_mul_i32 s53, s54, 160
    buffer_load_dwordx4 v[16:19], v9, s[8:11], s53 offen
    s_mov_b32 s3, 0
L_poll_77:
    s_add_u32 s3, s3, 1
    s_cmp_gt_u32 s3, 200000
    s_cbranch_scc1 L_pdone_79
    buffer_load_dword v126, v10, s[16:19], 0 offen sc1
L_chk_78:
    s_waitcnt vmcnt(0)
    v_mov_b32 v125, v126
    v_cmp_eq_u32 vcc, s52, v125
    s_cbranch_vccnz L_poll_77
L_pdone_79:
    v_and_b32 v122, 0xffff0000, v126
    v_rcp_f32 v124, v122
    v_lshlrev_b32 v120, 16, v126
    v_lshlrev_b32 v76, 16, v16
    v_and_b32 v77, 0xffff0000, v16
    v_lshlrev_b32 v78, 16, v17
    v_and_b32 v79, 0xffff0000, v17
    v_lshlrev_b32 v80, 16, v18
    v_and_b32 v81, 0xffff0000, v18
    v_lshlrev_b32 v82, 16, v19
    v_and_b32 v83, 0xffff0000, v19
    v_pk_add_f32 v[76:77], v[76:77], v[120:121] op_sel_hi:[1,0] neg_lo:[0,1] neg_hi:[0,1]
    v_pk_add_f32 v[78:79], v[78:79], v[120:121] op_sel_hi:[1,0] neg_lo:[0,1] neg_hi:[0,1]
    v_pk_add_f32 v[80:81], v[80:81], v[120:121] op_sel_hi:[1,0] neg_lo:[0,1] neg_hi:[0,1]
    v_pk_add_f32 v[82:83], v[82:83], v[120:121] op_sel_hi:[1,0] neg_lo:[0,1] neg_hi:[0,1]
    v_pk_mul_f32 v[76:77], v[76:77], v[124:125] op_sel_hi:[1,0]
    v_pk_mul_f32 v[78:79], v[78:79], v[124:125] op_sel_hi:[1,0]
    v_pk_mul_f32 v[80:81], v[80:81], v[124:125] op_sel_hi:[1,0]
    v_pk_mul_f32 v[82:83], v[82:83], v[124:125] op_sel_hi:[1,0]
    v_cvt_pk_bf16_f32 v16, v76, v77
    v_cvt_pk_bf16_f32 v17, v78, v79
    v_cvt_pk_bf16_f32 v18, v80, v81
    v_cvt_pk_bf16_f32 v19, v82, v83
    v_add_u32 v9, 152960, v2
    ds_write_b128 v9, v[16:19]
    s_mov_b64 exec, -1
    v_mov_b32 v9, 1
    ds_write_b32 v39, v9 offset:16
    s_setprio 0
    s_branch L_h13
L_hbulk:
    s_mov_b32 s53, 0
L_lp_80:
    ds_read_b32 v9, v39 offset:24
    s_add_u32 s53, s53, 1
    s_cmp_gt_u32 s53, 12800000
    s_cbranch_scc1 L_lo_81
    s_waitcnt lgkmcnt(0)
    v_readfirstlane_b32 s3, v9
    s_nop 0
    s_cmp_lt_u32 s3, 7
    s_cbranch_scc1 L_lp_80
L_lo_81:
    s_add_u32 s68, s68, 778240
    s_mov_b32 s69, 97280
    s_and_b32 s3, s55, 1
    s_lshl_b32 s3, s3, 10
    s_add_u32 s3, s3, 4096
    v_lshlrev_b32 v120, 7, v0
    v_mov_b32 v121, 1
    s_mov_b64 exec, 0xff
    buffer_atomic_add v121, v120, s[16:19], s3 offen sc1
    s_mov_b64 exec, -1
L_hb1:
    ds_read_b32 v9, v39 offset:20
    s_add_u32 m0, s69, 0
    s_nop 0
    buffer_load_dwordx4 v224, s[20:23], s68 offen offset:0 lds
    buffer_load_dwordx4 v225, s[20:23], s68 offen offset:1024 lds
    buffer_load_dwordx4 v226, s[20:23], s68 offen offset:2048 lds
    buffer_load_dwordx4 v227, s[20:23], s68 offen offset:3072 lds
    s_add_u32 m0, m0, 4096
    s_nop 0
    buffer_load_dwordx4 v228, s[20:23], s68 offen lds
    s_waitcnt vmcnt(30) lgkmcnt(0)
    v_readfirstlane_b32 s3, v9
    s_nop 0
    s_cmp_lt_u32 s3, 6
    s_cbranch_scc0 L_hb2
    s_waitcnt vmcnt(20)
L_hb2:
    s_sub_u32 s68, s68, 40960
    s_sub_u32 s69, s69, 5120
    s_cbranch_scc0 L_hb1
    s_mov_b32 s69, 0
    s_add_u32 m0, s69, 102400
    s_nop 0
    buffer_load_dwordx4 v224, s[8:11], s67 offen offset:0 lds
    buffer_load_dwordx4 v225, s[8:11], s67 offen offset:1024 lds
    buffer_load_dwordx4 v226, s[8:11], s67 offen offset:2048 lds
    buffer_load_dwordx4 v227, s[8:11], s67 offen offset:3072 lds
    s_add_u32 m0, m0, 4096
    s_nop 0
    buffer_load_dwordx4 v228, s[8:11], s67 offen lds
    s_add_u32 s67, s67, 40960
    s_add_u32 m0, s69, 107520
    s_nop 0
    buffer_load_dwordx4 v224, s[8:11], s67 offen offset:0 lds
    buffer_load_dwordx4 v225, s[8:11], s67 offen offset:1024 lds
    buffer_load_dwordx4 v226, s[8:11], s67 offen offset:2048 lds
    buffer_load_dwordx4 v227, s[8:11], s67 offen offset:3072 lds
    s_add_u32 m0, m0, 4096
    s_nop 0
    buffer_load_dwordx4 v228, s[8:11], s67 offen lds
    s_setprio 0
    s_lshr_b32 s3, s6, 3
    s_lshl3_add_u32 s50, s5, s3
    s_lshl_b32 s50, s50, 7
    s_add_u32 s50, s50, 57344
    s_lshl2_add_u32 s3, s5, s3
    s_and_b32 s53, s4, 3
    s_lshl2_add_u32 s51, s3, s53
    s_mul_i32 s48, s51, 20480
    s_add_u32 s45, s48, 4268032
    s_add_u32 s46, s45, 4096
    s_add_u32 s47, s48, 4278272
    s_and_b32 s3, s6, 7
    s_mul_i32 s3, s3, 160
    s_add_u32 s48, s48, s3
    v_lshlrev_b32 v7, 4, v0
    v_lshrrev_b32 v96, 4, v0
    v_bfe_u32 v97, v0, 2, 2
    v_and_b32 v98, 3, v0
    v_mul_u32_u24 v97, 160, v97
    v_lshl_add_u32 v97, v98, 3, v97
    v_add_u32 v97, 51200, v97
    v_lshrrev_b32 v98, 5, v0
    v_mul_u32_u24 v98, 3200, v98
    v_and_b32 v6, 1, v96
    v_mul_u32_u24 v6, 640, v6
    v_add3_u32 v6, v6, v98, v97
    v_mul_u32_u24 v2, 3200, v96
    v_add_u32 v2, v2, v97
    s_mul_i32 s3, s53, 2560
    s_add_u32 s3, s3, 133120
    v_and_b32 v97, 15, v0
    v_mul_u32_u24 v3, 160, v97
    v_lshl_add_u32 v3, v96, 3, v3
    v_add_u32 v3, s3, v3
    v_add_u32 v11, s3, v7
    s_mul_i32 s3, s53, 5120
    s_add_u32 s3, s3, 112640
    v_add_u32 v5, s3, v7
    v_mul_u32_u24 v96, 6554, v0
    s_movk_i32 s3, 1120
    v_cmp_gt_u32 vcc, 32, v0
    v_lshrrev_b32 v97, 16, v96
    v_mad_u32_u24 v8, v97, s3, v7
    v_add_u32 v96, 419456, v96
    v_lshrrev_b32 v97, 16, v96
    v_mad_u32_u24 v9, v97, s3, v7
    v_add_u32 v96, 419456, v96
    v_lshrrev_b32 v97, 16, v96
    v_mad_u32_u24 v10, v97, s3, v7
    v_mov_b32 v96, 0x7ff00000
    v_cndmask_b32 v10, v96, v10, vcc
    s_waitcnt vmcnt(0)
    s_branch L_h15
L_h13:
    s_cmp_lt_u32 s4, 4
    s_cbranch_scc0 L_h14
    s_lshr_b32 s3, s6, 3
    s_lshl3_add_u32 s50, s5, s3
    s_lshl_b32 s50, s50, 7
    s_add_u32 s50, s50, 57344
    s_lshl2_add_u32 s3, s5, s3
    s_and_b32 s53, s4, 3
    s_lshl2_add_u32 s51, s3, s53
    s_mul_i32 s48, s51, 20480
    s_add_u32 s45, s48, 4259840
    s_add_u32 s46, s45, 4096
    s_add_u32 s47, s48, 4276224
    s_and_b32 s3, s6, 7
    s_mul_i32 s3, s3, 160
    s_add_u32 s48, s48, s3
    s_lshl_b32 s49, s51, 6
    s_add_u32 s49, s49, 8192
    v_lshlrev_b32 v7, 4, v0
    v_lshrrev_b32 v96, 4, v0
    v_bfe_u32 v97, v0, 2, 2
    v_and_b32 v98, 3, v0
    v_mul_u32_u24 v97, 160, v97
    v_lshl_add_u32 v97, v98, 3, v97
    v_lshrrev_b32 v98, 5, v0
    v_mul_u32_u24 v98, 3200, v98
    v_and_b32 v6, 1, v96
    v_mul_u32_u24 v6, 640, v6
    v_add3_u32 v6, v6, v98, v97
    v_mul_u32_u24 v2, 3200, v96
    v_add_u32 v2, v2, v97
    s_mul_i32 s3, s53, 2560
    s_add_u32 s3, s3, 102400
    v_and_b32 v97, 15, v0
    v_mul_u32_u24 v3, 160, v97
    v_lshl_add_u32 v3, v96, 3, v3
    v_add_u32 v3, s3, v3
    v_lshlrev_b32 v4, 2, v97
    s_mul_i32 s3, s53, 5120
    s_add_u32 s3, s3, 112640
    v_add_u32 v5, s3, v7
    s_branch L_h15
L_h14:
    s_lshr_b32 s3, s6, 3
    s_lshl3_add_u32 s50, s5, s3
    s_lshl_b32 s50, s50, 7
    s_add_u32 s50, s50, 57344
    s_lshl2_add_u32 s3, s5, s3
    s_and_b32 s53, s4, 3
    s_lshl2_add_u32 s51, s3, s53
    s_mul_i32 s48, s51, 20480
    s_add_u32 s45, s48, 4268032
    s_add_u32 s46, s45, 4096
    s_add_u32 s47, s48, 4278272
    s_and_b32 s3, s6, 7
    s_mul_i32 s3, s3, 160
    s_add_u32 s48, s48, s3
    v_lshlrev_b32 v7, 4, v0
    v_lshrrev_b32 v96, 4, v0
    v_bfe_u32 v97, v0, 2, 2
    v_and_b32 v98, 3, v0
    v_mul_u32_u24 v97, 160, v97
    v_lshl_add_u32 v97, v98, 3, v97
    v_add_u32 v97, 51200, v97
    v_lshrrev_b32 v98, 5, v0
    v_mul_u32_u24 v98, 3200, v98
    v_and_b32 v6, 1, v96
    v_mul_u32_u24 v6, 640, v6
    v_add3_u32 v6, v6, v98, v97
    v_mul_u32_u24 v2, 3200, v96
    v_add_u32 v2, v2, v97
    s_mul_i32 s3, s53, 2560
    s_add_u32 s3, s3, 133120
    v_and_b32 v97, 15, v0
    v_mul_u32_u24 v3, 160, v97
    v_lshl_add_u32 v3, v96, 3, v3
    v_add_u32 v3, s3, v3
    v_add_u32 v11, s3, v7
    s_mul_i32 s3, s53, 5120
    s_add_u32 s3, s3, 112640
    v_add_u32 v5, s3, v7
    v_mul_u32_u24 v96, 6554, v0
    s_movk_i32 s3, 1120
    v_cmp_gt_u32 vcc, 32, v0
    v_lshrrev_b32 v97, 16, v96
    v_mad_u32_u24 v8, v97, s3, v7
    v_add_u32 v96, 419456, v96
    v_lshrrev_b32 v97, 16, v96
    v_mad_u32_u24 v9, v97, s3, v7
    v_add_u32 v96, 419456, v96
    v_lshrrev_b32 v97, 16, v96
    v_mad_u32_u24 v10, v97, s3, v7
    v_mov_b32 v96, 0x7ff00000
    v_cndmask_b32 v10, v96, v10, vcc
L_h15:
    s_waitcnt lgkmcnt(0)
    s_barrier
    ds_read_b64 v[122:123], v39
    s_waitcnt lgkmcnt(0)
    v_readfirstlane_b32 s100, v122
    v_readfirstlane_b32 s101, v123
    v_lshlrev_b32 v1, 3, v0
    s_mov_b32 s63, 0
    s_cmp_lt_u32 s4, 4
    s_cbranch_scc0 L_h16
    buffer_load_dword v229, v4, s[16:19], s49 offen sc1
    s_waitcnt vmcnt(0)
    v_mov_b32 v56, v229
    v_cmp_eq_u32 vcc, s52, v56
    s_cbranch_vccz L_ok_82
    s_mov_b32 s3, 0
L_poll_83:
    s_add_u32 s3, s3, 1
    s_cmp_gt_u32 s3, 200000
    s_cbranch_scc1 L_pdone_85
    buffer_load_dword v229, v4, s[16:19], s49 offen sc1
L_chk_84:
    s_waitcnt vmcnt(0)
    v_mov_b32 v56, v229
    v_cmp_eq_u32 vcc, s52, v56
    s_cbranch_vccnz L_poll_83
L_pdone_85:
L_ok_82:
    v_and_b32 v8, 0xffff0000, v229
    v_rcp_f32 v8, v8
    v_lshlrev_b32 v9, 16, v229
    s_not_b32 s3, s100
    s_bfe_u32 s3, s3, 0x70004
    s_cmp_eq_u32 s3, s51
    s_cselect_b32 s61, 1, 0
    v_mul_f32 v9, v9, v8
    v_add_f32 v8, 1.0, v8
    s_not_b32 s3, s101
    s_bfe_u32 s3, s3, 0x70004
    s_cmp_eq_u32 s3, s51
    s_cselect_b32 s3, 2, 0
    s_or_b32 s61, s61, s3
    s_branch L_c1
L_h16:
    v_lshlrev_b32 v4, 9, v0
    v_mov_b32 v38, 0
    s_branch L_c2h
L_end:
    s_endpgm
.section .rodata,"a"
.p2align 6
.amdhsa_kernel parallel_sum__linear_kernel_hedgehog__moe_arch_mod__prompt_kernel
  .amdhsa_next_free_vgpr 256
  .amdhsa_next_free_sgpr 102
  .amdhsa_accum_offset 256
  .amdhsa_group_segment_fixed_size 0
  .amdhsa_kernarg_size 96
  .amdhsa_user_sgpr_count 2
  .amdhsa_user_sgpr_kernarg_segment_ptr 1
  .amdhsa_system_sgpr_workgroup_id_x 1
.end_amdhsa_kernel
```
